```python
import torch

def _softmax(x, axis=-1):
    return torch.softmax(x, dim=axis)
def _gelu(x):
    return torch.nn.functional.gelu(x, approximate="tanh")
def _silu(x):
    return torch.nn.functional.silu(x)
def _sigmoid(x):
    return torch.sigmoid(x)
def _layernorm(x, axis=-1, eps=1e-5):
    m = x.mean(dim=axis, keepdim=True)
    v = x.var(dim=axis, keepdim=True, unbiased=False)
    return (x - m) / torch.sqrt(v + eps)
def _scatter_add(tgt, idx, src, axis=0):
    return tgt.clone().index_add_(axis, idx, src)
def _segment_sum(src, seg, n):
    out = torch.zeros((n,) + src.shape[1:], dtype=src.dtype)
    return out.index_add_(0, seg, src)
def _pad(x, pw):
    flat = tuple(v for pair in reversed(pw) for v in pair)
    return torch.nn.functional.pad(x, flat)

kernel_name = 'sequential_preLN__gqa_block_cached__geglu_ffn__decode'

def setup_inputs():

    _w = (lambda a: (lambda t: t.to(torch.bfloat16) if t.is_floating_point() else t)(torch.as_tensor(a)))
    def _A_setup():
        B, Sq, D = 1, 1, 576
        Hq, Hkv, Sk, Dh = 32, 16, 65536, 128
        assert Hq % Hkv == 0, (Hq, Hkv)
        return {
            "x": _w((lambda *s: torch.randn(*s, dtype=torch.bfloat16) * 0.05)(B, Sq, D)),
            "k_cache": _w((lambda *s: torch.randn(*s, dtype=torch.bfloat16) * 3.2)(B, Hkv, Sk, Dh)),
            "v_cache": _w((lambda *s: torch.randn(*s, dtype=torch.bfloat16) * 0.4)(B, Hkv, Sk, Dh)),
            "wq": _w((lambda *s: torch.randn(*s, dtype=torch.bfloat16) * 3.2)(D, Hq * Dh) * (D ** -0.5)),
            "wo": _w((lambda *s: torch.randn(*s, dtype=torch.bfloat16) * 0.4)(Hq * Dh, D) * ((Hq * Dh) ** -0.5)),
        }
    _A_in = _A_setup()

    def _B_setup():
        B, S, D, F = 1, 1, 576, 4608
        return {
            "x": _w((lambda *s: torch.randn(*s, dtype=torch.bfloat16) * 0.05)(B, S, D)),
            "w_gate": _w((lambda *s: torch.randn(*s, dtype=torch.bfloat16) * 0.05)(D, F)),
            "w_up": _w((lambda *s: torch.randn(*s, dtype=torch.bfloat16) * 0.05)(D, F)),
            "w_down": _w((lambda *s: torch.randn(*s, dtype=torch.bfloat16) * 0.05)(F, D)),
        }
    _B_in = _B_setup()

    return {
        "A_x": _A_in["x"],
        "A_k_cache": _A_in["k_cache"],
        "A_v_cache": _A_in["v_cache"],
        "A_wq": _A_in["wq"],
        "A_wo": _A_in["wo"],
        "B_x": _B_in["x"],
        "B_w_gate": _B_in["w_gate"],
        "B_w_up": _B_in["w_up"],
        "B_w_down": _B_in["w_down"],
    }

def reference(A_x, A_k_cache, A_v_cache, A_wq, A_wo, B_x, B_w_gate, B_w_up, B_w_down):
    def _A_ref(x, k_cache, v_cache, wq, wo):
        B, Sq, D = x.shape
        Hq, Dh = 32, 128
        Hkv = k_cache.shape[1]
        rep = Hq // Hkv
        q = (lambda x, *d: x.permute(*d))((x @ wq).reshape(B, Sq, Hq, Dh), 0, 2, 1, 3)
        k = (lambda x, n, axis: torch.repeat_interleave(x, n, dim=axis))(k_cache, rep, axis=1)
        v = (lambda x, n, axis: torch.repeat_interleave(x, n, dim=axis))(v_cache, rep, axis=1)
        scores = torch.einsum("bhqd,bhkd->bhqk", q, k) * (Dh ** -0.5)
        p = _softmax(scores, axis=-1)
        o = torch.einsum("bhqk,bhkd->bhqd", p, v)
        return (lambda x, *d: x.permute(*d))(o, 0, 2, 1, 3).reshape(B, Sq, Hq * Dh) @ wo

    def _B_ref(x, w_gate, w_up, w_down):
        return (_gelu(x @ w_gate) * (x @ w_up)) @ w_down

    x = A_x
    h = x + _A_ref(_layernorm(x, axis=-1), A_k_cache, A_v_cache, A_wq, A_wo)
    h2 = h + _B_ref(_layernorm(h, axis=-1), B_w_gate, B_w_up, B_w_down)
    return h2
```

```asm
; @launch grid=(256,1,1) block=(320,1,1) lds=147456
.amdgcn_target "amdgcn-amd-amdhsa--gfx950"
.text
.globl sequential_preLN__gqa_block_cached__geglu_ffn__decode_kernel
.p2align 8
.type sequential_preLN__gqa_block_cached__geglu_ffn__decode_kernel,@function
sequential_preLN__gqa_block_cached__geglu_ffn__decode_kernel:
    s_cmp_ge_u32 s2, 256
    s_cbranch_scc1 L_end
    s_load_dwordx16 s[4:19], s[0:1], 0
    s_load_dwordx8 s[20:27], s[0:1], 64
    v_lshrrev_b32 v9, 6, v0
    v_and_b32 v1, 63, v0
    v_readfirstlane_b32 s3, v9
    v_lshlrev_b32 v4, 4, v1
    v_lshrrev_b32 v9, 3, v1
    v_lshlrev_b32 v9, 13, v9
    v_and_b32 v10, 7, v1
    v_lshl_add_u32 v9, v10, 4, v9
    v_lshlrev_b32 v15, 1, v1
    v_and_b32 v10, 3, v1
    v_lshlrev_b32 v2, 4, v10
    v_bfe_u32 v14, v1, 2, 2
    v_lshl_add_u32 v2, v14, 8, v2
    v_lshrrev_b32 v13, 4, v1
    v_lshl_add_u32 v2, v13, 6, v2
    s_lshr_b32 s52, s2, 4
    s_and_b32 s53, s2, 15
    s_lshr_b32 s70, s2, 6
    s_and_b32 s71, s2, 63
    s_mul_i32 s65, s3, 5
    s_sub_u32 s65, s65, 2
    s_cmp_eq_u32 s3, 0
    s_cselect_b32 s65, 0, s65
    s_mul_i32 s64, s70, 18
    s_add_u32 s64, s64, s65
    s_lshl_b32 s64, s64, 16
    s_lshl_b32 s66, s71, 7
    s_add_u32 s64, s64, s66
    s_lshl_b32 s65, s65, 10
    s_add_u32 s65, s65, 110624
    s_lshl_b32 s57, s53, 18
    s_lshl_b32 s66, s3, 13
    s_add_u32 s57, s57, s66
    s_lshl_b32 s67, s52, 24
    s_waitcnt lgkmcnt(0)
    s_mov_b32 s40, s10
    s_and_b32 s41, s11, 0xffff
    s_mov_b32 s42, 4718592
    s_mov_b32 s43, 0x20000
    s_cmp_eq_u32 s3, 4
    s_cbranch_scc1 L_noring
    s_cmp_lg_u32 s3, 0
    s_cbranch_scc1 L_wq5
    s_mov_b32 s44, s4
    s_and_b32 s45, s5, 0xffff
    s_mov_b32 s46, 1152
    s_mov_b32 s47, 0x20000
    buffer_load_dwordx4 v[88:91], v4, s[44:47], 0 offen
    buffer_load_ushort v92, v15, s[44:47], 0 offen offset:1024
    s_branch L_wq3
L_wq5:
    s_mov_b32 m0, s65
    s_add_u32 s65, s65, 1024
    buffer_load_dwordx4 v9, s[40:43], s64 offen nt lds
    s_add_u32 s64, s64, 65536
    s_mov_b32 m0, s65
    s_add_u32 s65, s65, 1024
    buffer_load_dwordx4 v9, s[40:43], s64 offen nt lds
    s_add_u32 s64, s64, 65536
L_wq3:
    s_mov_b32 m0, s65
    s_add_u32 s65, s65, 1024
    buffer_load_dwordx4 v9, s[40:43], s64 offen nt lds
    s_add_u32 s64, s64, 65536
    s_mov_b32 m0, s65
    s_add_u32 s65, s65, 1024
    buffer_load_dwordx4 v9, s[40:43], s64 offen nt lds
    s_add_u32 s64, s64, 65536
    s_mov_b32 m0, s65
    s_add_u32 s65, s65, 1024
    buffer_load_dwordx4 v9, s[40:43], s64 offen nt lds
    s_add_u32 s64, s64, 65536
    s_add_u32 s28, s6, s67
    s_addc_u32 s29, s7, 0
    s_and_b32 s29, s29, 0xffff
    s_mov_b32 s30, 16777216
    s_mov_b32 s31, 0x20000
    buffer_load_dwordx4 v[56:59], v2, s[28:31], s57 offen offset:0 nt
    buffer_load_dwordx4 v[60:63], v2, s[28:31], s57 offen offset:1024 nt
    buffer_load_dwordx4 v[64:67], v2, s[28:31], s57 offen offset:2048 nt
    buffer_load_dwordx4 v[68:71], v2, s[28:31], s57 offen offset:3072 nt
    s_add_u32 s64, s57, 4096
    buffer_load_dwordx4 v[72:75], v2, s[28:31], s64 offen offset:0 nt
    buffer_load_dwordx4 v[76:79], v2, s[28:31], s64 offen offset:1024 nt
    buffer_load_dwordx4 v[80:83], v2, s[28:31], s64 offen offset:2048 nt
    buffer_load_dwordx4 v[84:87], v2, s[28:31], s64 offen offset:3072 nt
L_noring:
    s_load_dword s56, s[26:27], 0
    s_mov_b32 s44, s4
    s_and_b32 s45, s5, 0xffff
    s_mov_b32 s46, 1152
    s_mov_b32 s47, 0x20000
    s_mov_b32 s36, s26
    s_and_b32 s37, s27, 0xffff
    s_mov_b32 s38, 2097152
    s_mov_b32 s39, 0x20000
    s_mov_b32 s48, s22
    s_and_b32 s49, s23, 0xffff
    s_mov_b32 s50, 1152
    s_mov_b32 s51, 0x20000
    s_add_u32 s28, s6, s67
    s_addc_u32 s29, s7, 0
    s_and_b32 s29, s29, 0xffff
    s_mov_b32 s30, 16777216
    s_mov_b32 s31, 0x20000
    s_add_u32 s32, s8, s67
    s_addc_u32 s33, s9, 0
    s_and_b32 s33, s33, 0xffff
    s_mov_b32 s34, 16777216
    s_mov_b32 s35, 0x20000
    s_mov_b32 s63, 1048576
    s_mov_b32 s82, 0x00010001
    s_mov_b32 s83, 0x00010001
    s_lshr_b32 s64, s2, 5
    s_add_u32 s65, s64, s2
    s_and_b32 s65, s65, 15
    s_sub_u32 s66, s65, 9
    s_lshl_b32 s66, s66, 1
    s_and_b32 s64, s52, 1
    s_add_u32 s66, s66, s64
    s_lshr_b32 s55, s2, 5
    s_mul_i32 s55, s55, 9
    s_add_u32 s55, s55, s65
    s_lshl_b32 s55, s55, 1
    s_add_u32 s64, s64, s55
    s_cmp_lt_u32 s66, 9
    s_cselect_b32 s54, 1, 2
    s_cmp_lt_u32 s65, 9
    s_cselect_b32 s54, 0, s54
    s_cselect_b32 s55, s64, s66
    s_cmp_eq_u32 s3, 4
    s_cbranch_scc1 L_w4
    s_mov_b32 s22, s65
    s_cmp_lg_u32 s3, 0
    s_cbranch_scc1 L_ln_done
    s_waitcnt vmcnt(11)
    v_lshlrev_b32 v94, 16, v88
    v_and_b32 v95, 0xffff0000, v88
    v_lshlrev_b32 v96, 16, v89
    v_and_b32 v97, 0xffff0000, v89
    v_lshlrev_b32 v98, 16, v90
    v_and_b32 v99, 0xffff0000, v90
    v_lshlrev_b32 v100, 16, v91
    v_and_b32 v101, 0xffff0000, v91
    v_lshlrev_b32 v102, 16, v92
    v_pk_add_f32 v[114:115], v[94:95], v[96:97]
    v_pk_add_f32 v[116:117], v[98:99], v[100:101]
    v_pk_add_f32 v[114:115], v[114:115], v[116:117]
    v_add_f32 v9, v114, v115
    v_add_f32 v9, v9, v102
    s_nop 1
    v_add_f32_dpp v9, v9, v9 row_ror:8 row_mask:0xf bank_mask:0xf
    s_nop 1
    v_add_f32_dpp v9, v9, v9 row_ror:4 row_mask:0xf bank_mask:0xf
    s_nop 1
    v_add_f32_dpp v9, v9, v9 row_ror:2 row_mask:0xf bank_mask:0xf
    s_nop 1
    v_add_f32_dpp v9, v9, v9 row_ror:1 row_mask:0xf bank_mask:0xf
    v_mov_b32 v10, v9
    s_nop 1
    v_permlane16_swap_b32 v9, v10
    v_add_f32 v9, v9, v10
    v_mov_b32 v10, v9
    s_nop 1
    v_permlane32_swap_b32 v9, v10
    v_add_f32 v9, v9, v10
    v_mul_f32 v114, 0xbae38e39, v9
    v_mul_f32 v115, 0xbae38e39, v9
    v_pk_add_f32 v[104:105], v[94:95], v[114:115]
    v_pk_add_f32 v[106:107], v[96:97], v[114:115]
    v_pk_add_f32 v[108:109], v[98:99], v[114:115]
    v_pk_add_f32 v[110:111], v[100:101], v[114:115]
    v_add_f32 v112, v102, v114
    v_pk_mul_f32 v[116:117], v[104:105], v[104:105]
    v_pk_fma_f32 v[116:117], v[106:107], v[106:107], v[116:117]
    v_pk_fma_f32 v[116:117], v[108:109], v[108:109], v[116:117]
    v_pk_fma_f32 v[116:117], v[110:111], v[110:111], v[116:117]
    v_add_f32 v11, v116, v117
    v_fmac_f32 v11, v112, v112
    s_nop 1
    v_add_f32_dpp v11, v11, v11 row_ror:8 row_mask:0xf bank_mask:0xf
    s_nop 1
    v_add_f32_dpp v11, v11, v11 row_ror:4 row_mask:0xf bank_mask:0xf
    s_nop 1
    v_add_f32_dpp v11, v11, v11 row_ror:2 row_mask:0xf bank_mask:0xf
    s_nop 1
    v_add_f32_dpp v11, v11, v11 row_ror:1 row_mask:0xf bank_mask:0xf
    v_mov_b32 v10, v11
    s_nop 1
    v_permlane16_swap_b32 v11, v10
    v_add_f32 v11, v11, v10
    v_mov_b32 v10, v11
    s_nop 1
    v_permlane32_swap_b32 v11, v10
    v_add_f32 v11, v11, v10
    v_cvt_pk_bf16_f32 v114, v114, v114
    v_lshlrev_b32 v114, 16, v114
    v_mov_b32 v115, v114
    v_mul_f32 v11, 0x3ae38e39, v11
    v_cvt_pk_bf16_f32 v11, v11, v11
    v_lshlrev_b32 v11, 16, v11
    v_add_f32 v11, 0x3727c5ac, v11
    v_cvt_pk_bf16_f32 v11, v11, v11
    v_lshlrev_b32 v11, 16, v11
    v_sqrt_f32 v11, v11
    v_pk_add_f32 v[104:105], v[94:95], v[114:115]
    v_pk_add_f32 v[106:107], v[96:97], v[114:115]
    v_pk_add_f32 v[108:109], v[98:99], v[114:115]
    v_pk_add_f32 v[110:111], v[100:101], v[114:115]
    v_add_f32 v112, v102, v114
    v_cvt_pk_bf16_f32 v11, v11, v11
    v_lshlrev_b32 v11, 16, v11
    v_rcp_f32 v114, v11
    v_cvt_pk_bf16_f32 v9, v104, v105
    v_lshlrev_b32 v104, 16, v9
    v_and_b32 v105, 0xffff0000, v9
    v_cvt_pk_bf16_f32 v9, v106, v107
    v_lshlrev_b32 v106, 16, v9
    v_and_b32 v107, 0xffff0000, v9
    v_cvt_pk_bf16_f32 v9, v108, v109
    v_lshlrev_b32 v108, 16, v9
    v_and_b32 v109, 0xffff0000, v9
    v_cvt_pk_bf16_f32 v9, v110, v111
    v_lshlrev_b32 v110, 16, v9
    v_and_b32 v111, 0xffff0000, v9
    v_cvt_pk_bf16_f32 v112, v112, v112
    v_lshlrev_b32 v112, 16, v112
    v_mul_f32 v9, v104, v114
    v_fma_f32 v10, -v9, v11, v104
    v_fma_f32 v104, v10, v114, v9
    v_mul_f32 v9, v105, v114
    v_fma_f32 v10, -v9, v11, v105
    v_fma_f32 v105, v10, v114, v9
    v_mul_f32 v9, v106, v114
    v_fma_f32 v10, -v9, v11, v106
    v_fma_f32 v106, v10, v114, v9
    v_mul_f32 v9, v107, v114
    v_fma_f32 v10, -v9, v11, v107
    v_fma_f32 v107, v10, v114, v9
    v_mul_f32 v9, v108, v114
    v_fma_f32 v10, -v9, v11, v108
    v_fma_f32 v108, v10, v114, v9
    v_mul_f32 v9, v109, v114
    v_fma_f32 v10, -v9, v11, v109
    v_fma_f32 v109, v10, v114, v9
    v_mul_f32 v9, v110, v114
    v_fma_f32 v10, -v9, v11, v110
    v_fma_f32 v110, v10, v114, v9
    v_mul_f32 v9, v111, v114
    v_fma_f32 v10, -v9, v11, v111
    v_fma_f32 v111, v10, v114, v9
    v_mul_f32 v9, v112, v114
    v_fma_f32 v10, -v9, v11, v112
    v_fma_f32 v112, v10, v114, v9
    v_cvt_pk_bf16_f32 v114, v104, v105
    v_cvt_pk_bf16_f32 v115, v106, v107
    v_cvt_pk_bf16_f32 v116, v108, v109
    v_cvt_pk_bf16_f32 v117, v110, v111
    v_cvt_pk_bf16_f32 v9, v112, v112
    v_add_u32 v10, 129056, v4
    v_add_u32 v11, 129056, v15
    ds_write_b128 v10, v[114:117]
    ds_write_b16 v11, v9 offset:1024
L_ln_done:
    v_lshl_add_u32 v10, v13, 2, v14
    v_lshlrev_b32 v10, 7, v10
    v_and_b32 v9, 3, v1
    v_lshl_add_u32 v10, v9, 3, v10
    s_lshl_b32 s64, s3, 5
    s_add_u32 s64, s64, 110624
    v_add_u32 v10, s64, v10
    s_mul_i32 s64, s70, 288
    s_add_u32 s64, s64, 129056
    v_lshl_add_u32 v12, v13, 3, s64
    s_lshl_b32 s70, s70, 15
    s_lshl_b32 s71, s71, 9
    s_add_u32 s70, s70, s71
    s_lshl_b32 s71, s3, 7
    s_add_u32 s70, s70, s71
    s_add_u32 s70, s70, 851968
    s_lshl_b32 s71, s52, 11
    s_lshl_b32 s64, s3, 9
    s_add_u32 s71, s71, s64
    s_add_u32 s71, s71, 851968
    v_lshlrev_b32 v11, 3, v1
    v_and_b32 v9, 15, v1
    v_lshlrev_b32 v9, 5, v9
    v_lshl_add_u32 v14, v13, 15, v9
    v_and_b32 v15, 15, v1
    v_lshlrev_b32 v15, 3, v15
    v_and_b32 v9, 1, v13
    v_lshl_add_u32 v15, v9, 2, v15
    v_and_b32 v9, 2, v13
    v_add_u32 v15, v9, v15
    s_lshl_b32 s64, s3, 7
    s_add_u32 s64, s64, 130208
    v_add_u32 v15, s64, v15
    s_waitcnt vmcnt(8) lgkmcnt(0)
    s_barrier
    ds_read_b64_tr_b16 v[120:121], v10 offset:0
    ds_read_b64 v[122:123], v12 offset:0
    ds_read_b64_tr_b16 v[124:125], v10 offset:2048
    ds_read_b64 v[126:127], v12 offset:32
    ds_read_b64_tr_b16 v[128:129], v10 offset:4096
    ds_read_b64 v[130:131], v12 offset:64
    ds_read_b64_tr_b16 v[132:133], v10 offset:6144
    ds_read_b64 v[134:135], v12 offset:96
    ds_read_b64_tr_b16 v[136:137], v10 offset:8192
    ds_read_b64 v[138:139], v12 offset:128
    ds_read_b64_tr_b16 v[140:141], v10 offset:10240
    ds_read_b64 v[142:143], v12 offset:160
    ds_read_b64_tr_b16 v[144:145], v10 offset:12288
    ds_read_b64 v[146:147], v12 offset:192
    s_add_u32 s56, s56, 2654435769
    v_mov_b32 v89, s56
    s_waitcnt lgkmcnt(12)
    v_mfma_f32_16x16x16_bf16 v[40:43], v[122:123], v[120:121], 0
    ds_read_b64_tr_b16 v[148:149], v10 offset:14336
    ds_read_b64 v[150:151], v12 offset:224
    s_waitcnt lgkmcnt(12)
    v_mfma_f32_16x16x16_bf16 v[40:43], v[126:127], v[124:125], v[40:43]
    ds_read_b64_tr_b16 v[152:153], v10 offset:16384
    ds_read_b64 v[154:155], v12 offset:256
    s_waitcnt lgkmcnt(12)
    v_mfma_f32_16x16x16_bf16 v[40:43], v[130:131], v[128:129], v[40:43]
    s_waitcnt lgkmcnt(10)
    v_mfma_f32_16x16x16_bf16 v[40:43], v[134:135], v[132:133], v[40:43]
    s_waitcnt lgkmcnt(8)
    v_mfma_f32_16x16x16_bf16 v[40:43], v[138:139], v[136:137], v[40:43]
    s_waitcnt lgkmcnt(6)
    v_mfma_f32_16x16x16_bf16 v[40:43], v[142:143], v[140:141], v[40:43]
    s_waitcnt lgkmcnt(4)
    v_mfma_f32_16x16x16_bf16 v[40:43], v[146:147], v[144:145], v[40:43]
    s_waitcnt lgkmcnt(2)
    v_mfma_f32_16x16x16_bf16 v[40:43], v[150:151], v[148:149], v[40:43]
    s_waitcnt lgkmcnt(0)
    v_mfma_f32_16x16x16_bf16 v[40:43], v[154:155], v[152:153], v[40:43]
    s_nop 7
    v_mov_b32 v88, v40
    s_mov_b64 exec, 0xffff
    buffer_store_dwordx2 v[88:89], v11, s[36:39], s70 offen sc1
    s_mov_b64 exec, -1
    s_waitcnt vmcnt(0)
L_qpoll:
    buffer_load_dwordx4 v[92:95], v14, s[36:39], s71 offen sc1
    buffer_load_dwordx4 v[96:99], v14, s[36:39], s71 offen offset:16 sc1
    s_waitcnt vmcnt(0)
    v_cmp_ne_u32 vcc, s56, v93
    v_cmp_ne_u32 s[80:81], s56, v95
    s_nop 0
    s_or_b64 vcc, vcc, s[80:81]
    v_cmp_ne_u32 s[80:81], s56, v97
    s_nop 0
    s_or_b64 vcc, vcc, s[80:81]
    v_cmp_ne_u32 s[80:81], s56, v99
    s_nop 0
    s_or_b64 vcc, vcc, s[80:81]
    s_cbranch_vccz L_qok
    s_sleep 3
    s_sub_u32 s63, s63, 1
    s_cmp_eq_u32 s63, 0
    s_cbranch_scc1 L_end
    s_branch L_qpoll
L_qok:
    v_permlane32_swap_b32 v92, v94
    v_permlane32_swap_b32 v96, v98
    v_add_f32 v92, v92, v94
    v_add_f32 v96, v96, v98
    s_nop 1
    v_permlane16_swap_b32 v92, v96
    v_add_f32 v92, v92, v96
    v_cvt_pk_bf16_f32 v10, v92, v92
    ds_write_b16 v15, v10
    v_mov_b32 v9, 130784
    v_mov_b32 v10, 1
    s_mov_b64 exec, 1
    ds_add_u32 v9, v10 offset:0
    s_mov_b64 exec, -1
    s_mov_b32 s68, 0xf000f0
    s_mov_b32 s69, 0xf000f0
    s_mov_b32 s18, 0xf000f000
    s_mov_b32 s19, 0xf000f000
    s_mov_b32 s72, 0xff00ff00
    s_mov_b32 s73, 0xff00ff00
    s_mov_b32 s74, 0xcccccccc
    s_mov_b32 s75, 0xcccccccc
    s_mov_b32 s76, 0x3db504f3
    s_mov_b32 s77, 0x3fb8aa3b
    v_and_b32 v10, 1, v1
    v_lshlrev_b32 v14, 8, v10
    v_lshrrev_b32 v11, 2, v1
    v_lshl_add_u32 v14, v11, 4, v14
    v_add_u32 v14, 130208, v14
    v_cmp_eq_u32 vcc, 1, v10
    v_mov_b32 v11, 0xffff
    v_mov_b32 v12, 0xffff0000
    v_cndmask_b32 v6, v11, v12, vcc
    v_mov_b32 v7, 0xff7fffff
    v_mov_b32 v8, 0
    v_mov_b32 v3, 0xff800000
    v_mov_b32 v16, 0
    v_mov_b32 v17, 0
    v_mov_b32 v18, 0
    v_mov_b32 v19, 0
    v_mov_b32 v32, 0
    v_mov_b32 v237, 0
    v_mov_b32 v33, 0
    v_mov_b32 v238, 0
    v_mov_b32 v34, 0
    v_mov_b32 v239, 0
    v_mov_b32 v35, 0
    v_mov_b32 v240, 0
    v_mov_b32 v36, 0
    v_mov_b32 v241, 0
    v_mov_b32 v37, 0
    v_mov_b32 v242, 0
    v_mov_b32 v38, 0
    v_mov_b32 v243, 0
    v_mov_b32 v39, 0
    v_mov_b32 v244, 0
    v_mov_b32 v246, 0
    s_mov_b32 s20, s57
    s_mul_i32 s64, s3, 3584
    s_add_u32 s64, s64, 133120
    v_lshl_add_u32 v235, v1, 1, s64
    v_mov_b32 v236, 0
    s_mov_b32 s58, 27
    s_mov_b32 s59, 0
    s_lshl_b32 s61, s52, 2
    s_add_u32 s61, s61, s3
    s_mul_i32 s61, s61, 256
    s_add_u32 s61, s61, 1048576
    s_mul_i32 s62, s3, 128
    s_cmp_eq_u32 s54, 0
    s_cselect_b32 s21, 30, 0x7fff
    s_mul_i32 s64, s3, 3584
    s_add_u32 s64, s64, 133120
    v_and_b32 v9, 15, v1
    v_lshlrev_b32 v9, 5, v9
    v_lshl_add_u32 v9, v13, 3, v9
    v_add_u32 v5, s64, v9
    v_mov_b32 v9, 130784
L_lw1:
    ds_read_b32 v10, v9 offset:0
    s_waitcnt lgkmcnt(0)
    v_cmp_eq_u32 vcc, 4, v10
    s_cbranch_vccnz L_lw1ok
    s_sub_u32 s63, s63, 1
    s_cmp_eq_u32 s63, 0
    s_cbranch_scc1 L_end
    s_branch L_lw1
L_lw1ok:
    ds_read_b128 v[252:255], v14
    s_waitcnt lgkmcnt(0)
    v_cndmask_b32 v20, v252, 0, s[74:75]
    v_cndmask_b32 v24, 0, v252, s[74:75]
    v_cndmask_b32 v21, v253, 0, s[74:75]
    v_cndmask_b32 v25, 0, v253, s[74:75]
    v_cndmask_b32 v22, v254, 0, s[74:75]
    v_cndmask_b32 v26, 0, v254, s[74:75]
    v_cndmask_b32 v23, v255, 0, s[74:75]
    v_cndmask_b32 v27, 0, v255, s[74:75]
L_kstat:
    s_add_u32 s59, s59, 1
    s_and_b32 s64, s59, 7
    s_cselect_b32 s64, 0, 3932160
    s_add_u32 s57, s57, s64
    s_add_u32 s57, s57, 32768
    s_add_u32 s23, s57, 4096
    s_waitcnt vmcnt(5)
    v_mfma_f32_16x16x32_bf16 v[40:43], v[56:59], v[20:23], 0
    buffer_load_dwordx4 v[56:59], v2, s[28:31], s57 offen offset:0 nt
    s_waitcnt vmcnt(5)
    v_mfma_f32_16x16x32_bf16 v[40:43], v[60:63], v[24:27], v[40:43]
    buffer_load_dwordx4 v[60:63], v2, s[28:31], s57 offen offset:1024 nt
    s_waitcnt vmcnt(5)
    v_mfma_f32_16x16x32_bf16 v[44:47], v[64:67], v[20:23], 0
    buffer_load_dwordx4 v[64:67], v2, s[28:31], s57 offen offset:2048 nt
    s_waitcnt vmcnt(5)
    v_mfma_f32_16x16x32_bf16 v[44:47], v[68:71], v[24:27], v[44:47]
    buffer_load_dwordx4 v[68:71], v2, s[28:31], s57 offen offset:3072 nt
    s_waitcnt vmcnt(5)
    v_mfma_f32_16x16x32_bf16 v[48:51], v[72:75], v[20:23], 0
    buffer_load_dwordx4 v[72:75], v2, s[28:31], s23 offen offset:0 nt
    s_waitcnt vmcnt(5)
    v_mfma_f32_16x16x32_bf16 v[48:51], v[76:79], v[24:27], v[48:51]
    buffer_load_dwordx4 v[76:79], v2, s[28:31], s23 offen offset:1024 nt
    s_waitcnt vmcnt(5)
    v_mfma_f32_16x16x32_bf16 v[52:55], v[80:83], v[20:23], 0
    buffer_load_dwordx4 v[80:83], v2, s[28:31], s23 offen offset:2048 nt
    s_waitcnt vmcnt(5)
    v_mfma_f32_16x16x32_bf16 v[52:55], v[84:87], v[24:27], v[52:55]
    buffer_load_dwordx4 v[84:87], v2, s[28:31], s23 offen offset:3072 nt
    v_add_f32_dpp v40, v41, v40 row_ror:12 row_mask:0xf bank_mask:0xf
    v_add_f32_dpp v45, v46, v45 row_ror:12 row_mask:0xf bank_mask:0xf
    v_add_f32_dpp v50, v51, v50 row_ror:12 row_mask:0xf bank_mask:0xf
    s_nop 3
    v_add_f32_dpp v55, v52, v55 row_ror:12 row_mask:0xf bank_mask:0xf
    v_add_f32_dpp v40, v42, v40 row_ror:8 row_mask:0xf bank_mask:0xf
    v_add_f32_dpp v45, v47, v45 row_ror:8 row_mask:0xf bank_mask:0xf
    v_add_f32_dpp v50, v48, v50 row_ror:8 row_mask:0xf bank_mask:0xf
    v_add_f32_dpp v55, v53, v55 row_ror:8 row_mask:0xf bank_mask:0xf
    v_add_f32_dpp v40, v43, v40 row_ror:4 row_mask:0xf bank_mask:0xf
    v_add_f32_dpp v45, v44, v45 row_ror:4 row_mask:0xf bank_mask:0xf
    v_add_f32_dpp v50, v49, v50 row_ror:4 row_mask:0xf bank_mask:0xf
    v_add_f32_dpp v55, v54, v55 row_ror:4 row_mask:0xf bank_mask:0xf
    v_cndmask_b32 v9, v40, v45, s[68:69]
    v_cndmask_b32 v10, v50, v55, s[18:19]
    v_cndmask_b32 v9, v9, v10, s[72:73]
    v_cvt_pk_bf16_f32 v9, v9, v9
    v_lshlrev_b32 v9, 16, v9
    v_mul_f32 v9, s76, v9
    v_cvt_pk_bf16_f32 v9, v9, v9
    v_lshlrev_b32 v9, 16, v9
    ds_write_b16_d16_hi v235, v9
    v_max_f32 v7, v7, v9
    v_add_u32 v235, 128, v235
    s_sub_u32 s58, s58, 1
    s_cmp_lg_u32 s58, 0
    s_cbranch_scc1 L_kstat
    s_mov_b32 s59, 0
    s_mov_b32 s57, s20
    s_add_u32 s23, s57, 4096
    s_waitcnt vmcnt(5)
    v_mfma_f32_16x16x32_bf16 v[40:43], v[56:59], v[20:23], 0
    buffer_load_dwordx4 v[56:59], v4, s[32:35], s57 offen offset:0 nt
    s_waitcnt vmcnt(5)
    v_mfma_f32_16x16x32_bf16 v[40:43], v[60:63], v[24:27], v[40:43]
    buffer_load_dwordx4 v[60:63], v4, s[32:35], s57 offen offset:1024 nt
    s_waitcnt vmcnt(5)
    v_mfma_f32_16x16x32_bf16 v[44:47], v[64:67], v[20:23], 0
    buffer_load_dwordx4 v[64:67], v4, s[32:35], s57 offen offset:2048 nt
    s_waitcnt vmcnt(5)
    v_mfma_f32_16x16x32_bf16 v[44:47], v[68:71], v[24:27], v[44:47]
    buffer_load_dwordx4 v[68:71], v4, s[32:35], s57 offen offset:3072 nt
    s_waitcnt vmcnt(5)
    v_mfma_f32_16x16x32_bf16 v[48:51], v[72:75], v[20:23], 0
    buffer_load_dwordx4 v[72:75], v4, s[32:35], s23 offen offset:0 nt
    s_waitcnt vmcnt(5)
    v_mfma_f32_16x16x32_bf16 v[48:51], v[76:79], v[24:27], v[48:51]
    buffer_load_dwordx4 v[76:79], v4, s[32:35], s23 offen offset:1024 nt
    s_waitcnt vmcnt(5)
    v_mfma_f32_16x16x32_bf16 v[52:55], v[80:83], v[20:23], 0
    buffer_load_dwordx4 v[80:83], v4, s[32:35], s23 offen offset:2048 nt
    s_waitcnt vmcnt(5)
    v_mfma_f32_16x16x32_bf16 v[52:55], v[84:87], v[24:27], v[52:55]
    buffer_load_dwordx4 v[84:87], v4, s[32:35], s23 offen offset:3072 nt
    v_add_f32_dpp v40, v41, v40 row_ror:12 row_mask:0xf bank_mask:0xf
    v_add_f32_dpp v45, v46, v45 row_ror:12 row_mask:0xf bank_mask:0xf
    v_add_f32_dpp v50, v51, v50 row_ror:12 row_mask:0xf bank_mask:0xf
    s_nop 3
    v_add_f32_dpp v55, v52, v55 row_ror:12 row_mask:0xf bank_mask:0xf
    v_add_f32_dpp v40, v42, v40 row_ror:8 row_mask:0xf bank_mask:0xf
    v_add_f32_dpp v45, v47, v45 row_ror:8 row_mask:0xf bank_mask:0xf
    v_add_f32_dpp v50, v48, v50 row_ror:8 row_mask:0xf bank_mask:0xf
    v_add_f32_dpp v55, v53, v55 row_ror:8 row_mask:0xf bank_mask:0xf
    v_add_f32_dpp v40, v43, v40 row_ror:4 row_mask:0xf bank_mask:0xf
    v_add_f32_dpp v45, v44, v45 row_ror:4 row_mask:0xf bank_mask:0xf
    v_add_f32_dpp v50, v49, v50 row_ror:4 row_mask:0xf bank_mask:0xf
    v_add_f32_dpp v55, v54, v55 row_ror:4 row_mask:0xf bank_mask:0xf
    v_cndmask_b32 v9, v40, v45, s[68:69]
    v_cndmask_b32 v10, v50, v55, s[18:19]
    v_cndmask_b32 v9, v9, v10, s[72:73]
    v_cvt_pk_bf16_f32 v9, v9, v9
    v_lshlrev_b32 v9, 16, v9
    v_mul_f32 v9, s76, v9
    v_cvt_pk_bf16_f32 v9, v9, v9
    v_lshlrev_b32 v9, 16, v9
    ds_write_b16_d16_hi v235, v9
    v_max_f32 v7, v7, v9
    v_add_u32 v235, 128, v235
    v_subrev_u32 v235, 3584, v235
    ds_read_u16_d16_hi v236, v235
    v_max_f32_dpp v7, v7, v7 quad_perm:[2,3,0,1] row_mask:0xf bank_mask:0xf
    s_nop 1
    v_max_f32_dpp v7, v7, v7 row_ror:4 row_mask:0xf bank_mask:0xf
    s_nop 1
    v_max_f32_dpp v7, v7, v7 row_ror:8 row_mask:0xf bank_mask:0xf
    v_mov_b32 v10, v7
    s_nop 1
    v_permlane16_swap_b32 v7, v10
    v_max_f32 v7, v7, v10
    v_mov_b32 v10, v7
    s_nop 1
    v_permlane32_swap_b32 v7, v10
    v_max_f32 v7, v7, v10
    s_mov_b32 s58, 27
L_static:
    s_add_u32 s59, s59, 1
    s_and_b32 s64, s59, 7
    s_cselect_b32 s64, 0, 3932160
    s_add_u32 s57, s57, s64
    s_add_u32 s57, s57, 32768
    s_add_u32 s23, s57, 4096
    s_waitcnt lgkmcnt(0)
    s_cmp_le_u32 s58, 3
    s_cbranch_scc1 L_extra
L_nochk:
    v_sub_f32 v10, v236, v7
    v_mul_f32 v10, s77, v10
    v_exp_f32 v10, v10
    v_add_u32 v235, 128, v235
    ds_read_u16_d16_hi v236, v235
    v_cvt_pk_bf16_f32 v28, v10, v10
    v_add_f32 v8, v8, v10
    s_nop 0
    v_mov_b32_dpp v29, v28 row_ror:4 row_mask:0xf bank_mask:0xf
    v_mov_b32_dpp v30, v28 row_ror:8 row_mask:0xf bank_mask:0xf
    v_mov_b32_dpp v31, v28 row_ror:12 row_mask:0xf bank_mask:0xf
    v_and_b32_dpp v32, v28, v6 quad_perm:[0,0,1,1] row_mask:0xf bank_mask:0x1
    v_and_b32_dpp v33, v29, v6 quad_perm:[0,0,1,1] row_mask:0xf bank_mask:0x2
    v_and_b32_dpp v34, v30, v6 quad_perm:[0,0,1,1] row_mask:0xf bank_mask:0x4
    v_and_b32_dpp v35, v31, v6 quad_perm:[0,0,1,1] row_mask:0xf bank_mask:0x8
    s_waitcnt vmcnt(5)
    s_nop 0
    v_mfma_f32_16x16x32_bf16 v[16:19], v[32:35], v[56:59], v[16:19]
    buffer_load_dwordx4 v[56:59], v4, s[32:35], s57 offen offset:0 nt
    v_and_b32_dpp v36, v28, v6 quad_perm:[2,2,3,3] row_mask:0xf bank_mask:0x1
    v_and_b32_dpp v37, v29, v6 quad_perm:[2,2,3,3] row_mask:0xf bank_mask:0x2
    v_and_b32_dpp v38, v30, v6 quad_perm:[2,2,3,3] row_mask:0xf bank_mask:0x4
    v_and_b32_dpp v39, v31, v6 quad_perm:[2,2,3,3] row_mask:0xf bank_mask:0x8
    s_waitcnt vmcnt(5)
    s_nop 0
    v_mfma_f32_16x16x32_bf16 v[16:19], v[36:39], v[60:63], v[16:19]
    buffer_load_dwordx4 v[60:63], v4, s[32:35], s57 offen offset:1024 nt
    v_and_b32_dpp v32, v31, v6 quad_perm:[0,0,1,1] row_mask:0xf bank_mask:0x1
    v_and_b32_dpp v33, v28, v6 quad_perm:[0,0,1,1] row_mask:0xf bank_mask:0x2
    v_and_b32_dpp v34, v29, v6 quad_perm:[0,0,1,1] row_mask:0xf bank_mask:0x4
    v_and_b32_dpp v35, v30, v6 quad_perm:[0,0,1,1] row_mask:0xf bank_mask:0x8
    s_waitcnt vmcnt(5)
    s_nop 0
    v_mfma_f32_16x16x32_bf16 v[16:19], v[32:35], v[64:67], v[16:19]
    buffer_load_dwordx4 v[64:67], v4, s[32:35], s57 offen offset:2048 nt
    v_and_b32_dpp v36, v31, v6 quad_perm:[2,2,3,3] row_mask:0xf bank_mask:0x1
    v_and_b32_dpp v37, v28, v6 quad_perm:[2,2,3,3] row_mask:0xf bank_mask:0x2
    v_and_b32_dpp v38, v29, v6 quad_perm:[2,2,3,3] row_mask:0xf bank_mask:0x4
    v_and_b32_dpp v39, v30, v6 quad_perm:[2,2,3,3] row_mask:0xf bank_mask:0x8
    s_waitcnt vmcnt(5)
    s_nop 0
    v_mfma_f32_16x16x32_bf16 v[16:19], v[36:39], v[68:71], v[16:19]
    buffer_load_dwordx4 v[68:71], v4, s[32:35], s57 offen offset:3072 nt
    v_and_b32_dpp v32, v30, v6 quad_perm:[0,0,1,1] row_mask:0xf bank_mask:0x1
    v_and_b32_dpp v33, v31, v6 quad_perm:[0,0,1,1] row_mask:0xf bank_mask:0x2
    v_and_b32_dpp v34, v28, v6 quad_perm:[0,0,1,1] row_mask:0xf bank_mask:0x4
    v_and_b32_dpp v35, v29, v6 quad_perm:[0,0,1,1] row_mask:0xf bank_mask:0x8
    s_waitcnt vmcnt(5)
    s_nop 0
    v_mfma_f32_16x16x32_bf16 v[16:19], v[32:35], v[72:75], v[16:19]
    buffer_load_dwordx4 v[72:75], v4, s[32:35], s23 offen offset:0 nt
    v_and_b32_dpp v36, v30, v6 quad_perm:[2,2,3,3] row_mask:0xf bank_mask:0x1
    v_and_b32_dpp v37, v31, v6 quad_perm:[2,2,3,3] row_mask:0xf bank_mask:0x2
    v_and_b32_dpp v38, v28, v6 quad_perm:[2,2,3,3] row_mask:0xf bank_mask:0x4
    v_and_b32_dpp v39, v29, v6 quad_perm:[2,2,3,3] row_mask:0xf bank_mask:0x8
    s_waitcnt vmcnt(5)
    s_nop 0
    v_mfma_f32_16x16x32_bf16 v[16:19], v[36:39], v[76:79], v[16:19]
    buffer_load_dwordx4 v[76:79], v4, s[32:35], s23 offen offset:1024 nt
    v_and_b32_dpp v32, v29, v6 quad_perm:[0,0,1,1] row_mask:0xf bank_mask:0x1
    v_and_b32_dpp v33, v30, v6 quad_perm:[0,0,1,1] row_mask:0xf bank_mask:0x2
    v_and_b32_dpp v34, v31, v6 quad_perm:[0,0,1,1] row_mask:0xf bank_mask:0x4
    v_and_b32_dpp v35, v28, v6 quad_perm:[0,0,1,1] row_mask:0xf bank_mask:0x8
    s_waitcnt vmcnt(5)
    s_nop 0
    v_mfma_f32_16x16x32_bf16 v[16:19], v[32:35], v[80:83], v[16:19]
    buffer_load_dwordx4 v[80:83], v4, s[32:35], s23 offen offset:2048 nt
    v_and_b32_dpp v36, v29, v6 quad_perm:[2,2,3,3] row_mask:0xf bank_mask:0x1
    v_and_b32_dpp v37, v30, v6 quad_perm:[2,2,3,3] row_mask:0xf bank_mask:0x2
    v_and_b32_dpp v38, v31, v6 quad_perm:[2,2,3,3] row_mask:0xf bank_mask:0x4
    v_and_b32_dpp v39, v28, v6 quad_perm:[2,2,3,3] row_mask:0xf bank_mask:0x8
    s_waitcnt vmcnt(5)
    s_nop 0
    v_mfma_f32_16x16x32_bf16 v[16:19], v[36:39], v[84:87], v[16:19]
    buffer_load_dwordx4 v[84:87], v4, s[32:35], s23 offen offset:3072 nt
    s_sub_u32 s58, s58, 1
    s_cmp_lg_u32 s58, 0
    s_cbranch_scc1 L_static
    s_mov_b32 s59, 0
    s_cmp_lg_u32 s59, 0
    s_cbranch_scc1 L_dyn2v
    s_waitcnt lgkmcnt(0)
    s_cmp_ge_u32 s60, 52
    s_cbranch_scc1 L_vdrain
    s_lshl_b32 s5, s60, 2
    s_mov_b32 s59, 4
    s_lshl_b32 s64, s60, 1
    s_add_u32 s64, s64, 40
    s_cmp_ge_u32 s60, 20
    s_cselect_b32 s5, s64, s5
    s_cselect_b32 s59, 2, s59
    s_lshl_b32 s64, s60, 0
    s_add_u32 s64, s64, 76
    s_cmp_ge_u32 s60, 36
    s_cselect_b32 s5, s64, s5
    s_cselect_b32 s59, 1, s59
    s_add_u32 s5, s5, s62
    s_mul_i32 s64, s5, 2048
    s_lshr_b32 s64, s64, 16
    s_mul_i32 s64, s64, 32
    s_add_u32 s5, s5, s64
    s_add_u32 s5, s5, 3104
    s_lshl_b32 s5, s5, 12
L_dyn2v:
    s_mov_b32 s57, s5
    s_add_u32 s5, s5, 4096
    s_sub_u32 s59, s59, 1
    s_cmp_lg_u32 s59, 0
    s_cbranch_scc1 L_dyn3v
    s_cmp_ge_u32 s60, s21
    s_cselect_b32 s60, 0x7fff, s60
    s_cbranch_scc1 L_dyn3v
    s_mov_b32 s60, 1
    s_atomic_add s60, s[26:27], s61 glc
L_dyn3v:
    v_sub_f32 v10, v236, v7
    v_mul_f32 v10, s77, v10
    v_exp_f32 v10, v10
    s_nop 0
    v_cvt_pk_bf16_f32 v28, v10, v10
    v_add_f32 v8, v8, v10
    s_nop 0
    v_mov_b32_dpp v29, v28 row_ror:4 row_mask:0xf bank_mask:0xf
    v_mov_b32_dpp v30, v28 row_ror:8 row_mask:0xf bank_mask:0xf
    v_mov_b32_dpp v31, v28 row_ror:12 row_mask:0xf bank_mask:0xf
    v_and_b32_dpp v32, v28, v6 quad_perm:[0,0,1,1] row_mask:0xf bank_mask:0x1
    v_and_b32_dpp v33, v29, v6 quad_perm:[0,0,1,1] row_mask:0xf bank_mask:0x2
    v_and_b32_dpp v34, v30, v6 quad_perm:[0,0,1,1] row_mask:0xf bank_mask:0x4
    v_and_b32_dpp v35, v31, v6 quad_perm:[0,0,1,1] row_mask:0xf bank_mask:0x8
    s_waitcnt vmcnt(7)
    s_nop 0
    v_mfma_f32_16x16x32_bf16 v[16:19], v[32:35], v[56:59], v[16:19]
    buffer_load_dwordx4 v[56:59], v2, s[28:31], s57 offen offset:0 nt
    v_and_b32_dpp v36, v28, v6 quad_perm:[2,2,3,3] row_mask:0xf bank_mask:0x1
    v_and_b32_dpp v37, v29, v6 quad_perm:[2,2,3,3] row_mask:0xf bank_mask:0x2
    v_and_b32_dpp v38, v30, v6 quad_perm:[2,2,3,3] row_mask:0xf bank_mask:0x4
    v_and_b32_dpp v39, v31, v6 quad_perm:[2,2,3,3] row_mask:0xf bank_mask:0x8
    s_waitcnt vmcnt(7)
    s_nop 0
    v_mfma_f32_16x16x32_bf16 v[16:19], v[36:39], v[60:63], v[16:19]
    buffer_load_dwordx4 v[60:63], v2, s[28:31], s57 offen offset:1024 nt
    v_and_b32_dpp v32, v31, v6 quad_perm:[0,0,1,1] row_mask:0xf bank_mask:0x1
    v_and_b32_dpp v33, v28, v6 quad_perm:[0,0,1,1] row_mask:0xf bank_mask:0x2
    v_and_b32_dpp v34, v29, v6 quad_perm:[0,0,1,1] row_mask:0xf bank_mask:0x4
    v_and_b32_dpp v35, v30, v6 quad_perm:[0,0,1,1] row_mask:0xf bank_mask:0x8
    s_waitcnt vmcnt(7)
    s_nop 0
    v_mfma_f32_16x16x32_bf16 v[16:19], v[32:35], v[64:67], v[16:19]
    buffer_load_dwordx4 v[64:67], v2, s[28:31], s57 offen offset:2048 nt
    v_and_b32_dpp v36, v31, v6 quad_perm:[2,2,3,3] row_mask:0xf bank_mask:0x1
    v_and_b32_dpp v37, v28, v6 quad_perm:[2,2,3,3] row_mask:0xf bank_mask:0x2
    v_and_b32_dpp v38, v29, v6 quad_perm:[2,2,3,3] row_mask:0xf bank_mask:0x4
    v_and_b32_dpp v39, v30, v6 quad_perm:[2,2,3,3] row_mask:0xf bank_mask:0x8
    s_waitcnt vmcnt(7)
    s_nop 0
    v_mfma_f32_16x16x32_bf16 v[16:19], v[36:39], v[68:71], v[16:19]
    buffer_load_dwordx4 v[68:71], v2, s[28:31], s57 offen offset:3072 nt
    v_and_b32_dpp v32, v30, v6 quad_perm:[0,0,1,1] row_mask:0xf bank_mask:0x1
    v_and_b32_dpp v33, v31, v6 quad_perm:[0,0,1,1] row_mask:0xf bank_mask:0x2
    v_and_b32_dpp v34, v28, v6 quad_perm:[0,0,1,1] row_mask:0xf bank_mask:0x4
    v_and_b32_dpp v35, v29, v6 quad_perm:[0,0,1,1] row_mask:0xf bank_mask:0x8
    s_waitcnt vmcnt(7)
    s_nop 0
    v_mfma_f32_16x16x32_bf16 v[16:19], v[32:35], v[72:75], v[16:19]
    buffer_load_dwordx4 v[72:75], v4, s[32:35], s57 offen offset:0 nt
    v_and_b32_dpp v36, v30, v6 quad_perm:[2,2,3,3] row_mask:0xf bank_mask:0x1
    v_and_b32_dpp v37, v31, v6 quad_perm:[2,2,3,3] row_mask:0xf bank_mask:0x2
    v_and_b32_dpp v38, v28, v6 quad_perm:[2,2,3,3] row_mask:0xf bank_mask:0x4
    v_and_b32_dpp v39, v29, v6 quad_perm:[2,2,3,3] row_mask:0xf bank_mask:0x8
    s_waitcnt vmcnt(7)
    s_nop 0
    v_mfma_f32_16x16x32_bf16 v[16:19], v[36:39], v[76:79], v[16:19]
    buffer_load_dwordx4 v[76:79], v4, s[32:35], s57 offen offset:1024 nt
    v_and_b32_dpp v32, v29, v6 quad_perm:[0,0,1,1] row_mask:0xf bank_mask:0x1
    v_and_b32_dpp v33, v30, v6 quad_perm:[0,0,1,1] row_mask:0xf bank_mask:0x2
    v_and_b32_dpp v34, v31, v6 quad_perm:[0,0,1,1] row_mask:0xf bank_mask:0x4
    v_and_b32_dpp v35, v28, v6 quad_perm:[0,0,1,1] row_mask:0xf bank_mask:0x8
    s_waitcnt vmcnt(7)
    s_nop 0
    v_mfma_f32_16x16x32_bf16 v[16:19], v[32:35], v[80:83], v[16:19]
    buffer_load_dwordx4 v[80:83], v4, s[32:35], s57 offen offset:2048 nt
    v_and_b32_dpp v36, v29, v6 quad_perm:[2,2,3,3] row_mask:0xf bank_mask:0x1
    v_and_b32_dpp v37, v30, v6 quad_perm:[2,2,3,3] row_mask:0xf bank_mask:0x2
    v_and_b32_dpp v38, v31, v6 quad_perm:[2,2,3,3] row_mask:0xf bank_mask:0x4
    v_and_b32_dpp v39, v28, v6 quad_perm:[2,2,3,3] row_mask:0xf bank_mask:0x8
    s_waitcnt vmcnt(7)
    s_nop 0
    v_mfma_f32_16x16x32_bf16 v[16:19], v[36:39], v[84:87], v[16:19]
    buffer_load_dwordx4 v[84:87], v4, s[32:35], s57 offen offset:3072 nt
L_dyn:
    s_cmp_lg_u32 s59, 0
    s_cbranch_scc1 L_dyn2
    s_waitcnt lgkmcnt(0)
    s_cmp_ge_u32 s60, 52
    s_cbranch_scc1 L_drain
    s_lshl_b32 s5, s60, 2
    s_mov_b32 s59, 4
    s_lshl_b32 s64, s60, 1
    s_add_u32 s64, s64, 40
    s_cmp_ge_u32 s60, 20
    s_cselect_b32 s5, s64, s5
    s_cselect_b32 s59, 2, s59
    s_lshl_b32 s64, s60, 0
    s_add_u32 s64, s64, 76
    s_cmp_ge_u32 s60, 36
    s_cselect_b32 s5, s64, s5
    s_cselect_b32 s59, 1, s59
    s_add_u32 s5, s5, s62
    s_mul_i32 s64, s5, 2048
    s_lshr_b32 s64, s64, 16
    s_mul_i32 s64, s64, 32
    s_add_u32 s5, s5, s64
    s_add_u32 s5, s5, 3104
    s_lshl_b32 s5, s5, 12
L_dyn2:
    s_mov_b32 s57, s5
    s_add_u32 s5, s5, 4096
    s_sub_u32 s59, s59, 1
    s_cmp_lg_u32 s59, 0
    s_cbranch_scc1 L_dyn3
    s_cmp_ge_u32 s60, s21
    s_cselect_b32 s60, 0x7fff, s60
    s_cbranch_scc1 L_dyn3
    s_mov_b32 s60, 1
    s_atomic_add s60, s[26:27], s61 glc
L_dyn3:
    s_waitcnt vmcnt(7)
    v_mfma_f32_16x16x32_bf16 v[40:43], v[56:59], v[20:23], 0
    buffer_load_dwordx4 v[56:59], v2, s[28:31], s57 offen offset:0 nt
    s_waitcnt vmcnt(7)
    v_mfma_f32_16x16x32_bf16 v[40:43], v[60:63], v[24:27], v[40:43]
    buffer_load_dwordx4 v[60:63], v2, s[28:31], s57 offen offset:1024 nt
    s_waitcnt vmcnt(7)
    v_mfma_f32_16x16x32_bf16 v[44:47], v[64:67], v[20:23], 0
    buffer_load_dwordx4 v[64:67], v2, s[28:31], s57 offen offset:2048 nt
    s_waitcnt vmcnt(7)
    v_mfma_f32_16x16x32_bf16 v[44:47], v[68:71], v[24:27], v[44:47]
    buffer_load_dwordx4 v[68:71], v2, s[28:31], s57 offen offset:3072 nt
    s_nop 0
    v_add_f32_dpp v40, v41, v40 row_ror:12 row_mask:0xf bank_mask:0xf
    s_nop 4
    v_add_f32_dpp v45, v46, v45 row_ror:12 row_mask:0xf bank_mask:0xf
    v_add_f32_dpp v40, v42, v40 row_ror:8 row_mask:0xf bank_mask:0xf
    s_nop 0
    v_add_f32_dpp v45, v47, v45 row_ror:8 row_mask:0xf bank_mask:0xf
    v_add_f32_dpp v40, v43, v40 row_ror:4 row_mask:0xf bank_mask:0xf
    s_nop 0
    v_add_f32_dpp v45, v44, v45 row_ror:4 row_mask:0xf bank_mask:0xf
    v_cndmask_b32 v9, v40, v45, s[68:69]
    v_cndmask_b32 v9, v9, v3, s[72:73]
    v_cvt_pk_bf16_f32 v9, v9, v9
    v_lshlrev_b32 v9, 16, v9
    v_mul_f32 v9, s76, v9
    v_cvt_pk_bf16_f32 v9, v9, v9
    v_lshlrev_b32 v9, 16, v9
    v_cmp_gt_f32 vcc, v9, v7
    s_cbranch_vccnz L_rared
L_contd:
    v_sub_f32 v10, v9, v7
    v_mul_f32 v10, s77, v10
    v_exp_f32 v10, v10
    s_nop 0
    v_cvt_pk_bf16_f32 v28, v10, v10
    v_add_f32 v8, v8, v10
    s_nop 0
    v_mov_b32_dpp v29, v28 row_ror:4 row_mask:0xf bank_mask:0xf
    v_mov_b32_dpp v30, v28 row_ror:8 row_mask:0xf bank_mask:0xf
    v_mov_b32_dpp v31, v28 row_ror:12 row_mask:0xf bank_mask:0xf
    v_and_b32_dpp v32, v28, v6 quad_perm:[0,0,1,1] row_mask:0xf bank_mask:0x1
    v_and_b32_dpp v33, v29, v6 quad_perm:[0,0,1,1] row_mask:0xf bank_mask:0x2
    v_and_b32_dpp v34, v30, v6 quad_perm:[0,0,1,1] row_mask:0xf bank_mask:0x4
    v_and_b32_dpp v35, v31, v6 quad_perm:[0,0,1,1] row_mask:0xf bank_mask:0x8
    s_waitcnt vmcnt(7)
    s_nop 0
    v_mfma_f32_16x16x32_bf16 v[16:19], v[32:35], v[72:75], v[16:19]
    buffer_load_dwordx4 v[72:75], v4, s[32:35], s57 offen offset:0 nt
    v_and_b32_dpp v36, v28, v6 quad_perm:[2,2,3,3] row_mask:0xf bank_mask:0x1
    v_and_b32_dpp v37, v29, v6 quad_perm:[2,2,3,3] row_mask:0xf bank_mask:0x2
    v_and_b32_dpp v38, v30, v6 quad_perm:[2,2,3,3] row_mask:0xf bank_mask:0x4
    v_and_b32_dpp v39, v31, v6 quad_perm:[2,2,3,3] row_mask:0xf bank_mask:0x8
    s_waitcnt vmcnt(7)
    s_nop 0
    v_mfma_f32_16x16x32_bf16 v[16:19], v[36:39], v[76:79], v[16:19]
    buffer_load_dwordx4 v[76:79], v4, s[32:35], s57 offen offset:1024 nt
    v_and_b32_dpp v32, v31, v6 quad_perm:[0,0,1,1] row_mask:0xf bank_mask:0x1
    v_and_b32_dpp v33, v28, v6 quad_perm:[0,0,1,1] row_mask:0xf bank_mask:0x2
    v_and_b32_dpp v34, v29, v6 quad_perm:[0,0,1,1] row_mask:0xf bank_mask:0x4
    v_and_b32_dpp v35, v30, v6 quad_perm:[0,0,1,1] row_mask:0xf bank_mask:0x8
    s_waitcnt vmcnt(7)
    s_nop 0
    v_mfma_f32_16x16x32_bf16 v[16:19], v[32:35], v[80:83], v[16:19]
    buffer_load_dwordx4 v[80:83], v4, s[32:35], s57 offen offset:2048 nt
    v_and_b32_dpp v36, v31, v6 quad_perm:[2,2,3,3] row_mask:0xf bank_mask:0x1
    v_and_b32_dpp v37, v28, v6 quad_perm:[2,2,3,3] row_mask:0xf bank_mask:0x2
    v_and_b32_dpp v38, v29, v6 quad_perm:[2,2,3,3] row_mask:0xf bank_mask:0x4
    v_and_b32_dpp v39, v30, v6 quad_perm:[2,2,3,3] row_mask:0xf bank_mask:0x8
    s_waitcnt vmcnt(7)
    s_nop 0
    v_mfma_f32_16x16x32_bf16 v[16:19], v[36:39], v[84:87], v[16:19]
    buffer_load_dwordx4 v[84:87], v4, s[32:35], s57 offen offset:3072 nt
    s_branch L_dyn
L_vdrain:
    v_sub_f32 v10, v236, v7
    v_mul_f32 v10, s77, v10
    v_exp_f32 v10, v10
    s_nop 0
    v_cvt_pk_bf16_f32 v28, v10, v10
    v_add_f32 v8, v8, v10
    s_nop 0
    v_mov_b32_dpp v29, v28 row_ror:4 row_mask:0xf bank_mask:0xf
    v_mov_b32_dpp v30, v28 row_ror:8 row_mask:0xf bank_mask:0xf
    v_mov_b32_dpp v31, v28 row_ror:12 row_mask:0xf bank_mask:0xf
    v_add_f32_dpp v8, v8, v8 quad_perm:[2,3,0,1] row_mask:0xf bank_mask:0xf
    s_nop 1
    v_add_f32_dpp v8, v8, v8 row_ror:4 row_mask:0xf bank_mask:0xf
    s_nop 1
    v_add_f32_dpp v8, v8, v8 row_ror:8 row_mask:0xf bank_mask:0xf
    v_mov_b32 v10, v8
    s_nop 1
    v_permlane16_swap_b32 v8, v10
    v_add_f32 v8, v8, v10
    v_mov_b32 v10, v8
    s_nop 1
    v_permlane32_swap_b32 v8, v10
    v_add_f32 v8, v8, v10
    s_lshl_b32 s64, s3, 4
    s_add_u32 s64, s64, 130720
    v_lshl_add_u32 v9, v1, 3, s64
    v_mov_b32 v40, v7
    v_mov_b32 v41, v8
    s_mov_b64 exec, 3
    ds_write_b64 v9, v[40:41]
    s_mov_b64 exec, -1
    v_lshrrev_b32 v9, 5, v1
    v_lshlrev_b32 v15, 3, v9
    v_add_u32 v9, 130720, v15
    v_add_u32 v10, 133120, v4
    s_lshl_b32 s64, s2, 10
    s_add_u32 s64, s64, 131072
    s_lshl_b32 s65, s2, 7
    s_add_u32 s65, s65, 65536
    s_mov_b64 s[84:85], -1
    s_mov_b64 s[86:87], -1
    s_mov_b64 s[14:15], -1
    s_mov_b64 s[24:25], -1
    v_and_b32_dpp v32, v28, v6 quad_perm:[0,0,1,1] row_mask:0xf bank_mask:0x1
    v_and_b32_dpp v33, v29, v6 quad_perm:[0,0,1,1] row_mask:0xf bank_mask:0x2
    v_and_b32_dpp v34, v30, v6 quad_perm:[0,0,1,1] row_mask:0xf bank_mask:0x4
    v_and_b32_dpp v35, v31, v6 quad_perm:[0,0,1,1] row_mask:0xf bank_mask:0x8
    s_waitcnt vmcnt(7)
    s_nop 0
    v_mfma_f32_16x16x32_bf16 v[16:19], v[32:35], v[56:59], v[16:19]
    v_and_b32_dpp v36, v28, v6 quad_perm:[2,2,3,3] row_mask:0xf bank_mask:0x1
    v_and_b32_dpp v37, v29, v6 quad_perm:[2,2,3,3] row_mask:0xf bank_mask:0x2
    v_and_b32_dpp v38, v30, v6 quad_perm:[2,2,3,3] row_mask:0xf bank_mask:0x4
    v_and_b32_dpp v39, v31, v6 quad_perm:[2,2,3,3] row_mask:0xf bank_mask:0x8
    s_waitcnt vmcnt(6)
    s_nop 0
    v_mfma_f32_16x16x32_bf16 v[16:19], v[36:39], v[60:63], v[16:19]
    v_and_b32_dpp v32, v31, v6 quad_perm:[0,0,1,1] row_mask:0xf bank_mask:0x1
    v_and_b32_dpp v33, v28, v6 quad_perm:[0,0,1,1] row_mask:0xf bank_mask:0x2
    v_and_b32_dpp v34, v29, v6 quad_perm:[0,0,1,1] row_mask:0xf bank_mask:0x4
    v_and_b32_dpp v35, v30, v6 quad_perm:[0,0,1,1] row_mask:0xf bank_mask:0x8
    s_waitcnt vmcnt(5)
    s_nop 0
    v_mfma_f32_16x16x32_bf16 v[16:19], v[32:35], v[64:67], v[16:19]
    v_and_b32_dpp v36, v31, v6 quad_perm:[2,2,3,3] row_mask:0xf bank_mask:0x1
    v_and_b32_dpp v37, v28, v6 quad_perm:[2,2,3,3] row_mask:0xf bank_mask:0x2
    v_and_b32_dpp v38, v29, v6 quad_perm:[2,2,3,3] row_mask:0xf bank_mask:0x4
    v_and_b32_dpp v39, v30, v6 quad_perm:[2,2,3,3] row_mask:0xf bank_mask:0x8
    s_waitcnt vmcnt(4)
    s_nop 0
    v_mfma_f32_16x16x32_bf16 v[16:19], v[36:39], v[68:71], v[16:19]
    v_and_b32_dpp v32, v30, v6 quad_perm:[0,0,1,1] row_mask:0xf bank_mask:0x1
    v_and_b32_dpp v33, v31, v6 quad_perm:[0,0,1,1] row_mask:0xf bank_mask:0x2
    v_and_b32_dpp v34, v28, v6 quad_perm:[0,0,1,1] row_mask:0xf bank_mask:0x4
    v_and_b32_dpp v35, v29, v6 quad_perm:[0,0,1,1] row_mask:0xf bank_mask:0x8
    s_waitcnt vmcnt(3)
    s_nop 0
    v_mfma_f32_16x16x32_bf16 v[16:19], v[32:35], v[72:75], v[16:19]
    v_and_b32_dpp v36, v30, v6 quad_perm:[2,2,3,3] row_mask:0xf bank_mask:0x1
    v_and_b32_dpp v37, v31, v6 quad_perm:[2,2,3,3] row_mask:0xf bank_mask:0x2
    v_and_b32_dpp v38, v28, v6 quad_perm:[2,2,3,3] row_mask:0xf bank_mask:0x4
    v_and_b32_dpp v39, v29, v6 quad_perm:[2,2,3,3] row_mask:0xf bank_mask:0x8
    s_waitcnt vmcnt(2)
    s_nop 0
    v_mfma_f32_16x16x32_bf16 v[16:19], v[36:39], v[76:79], v[16:19]
    v_and_b32_dpp v32, v29, v6 quad_perm:[0,0,1,1] row_mask:0xf bank_mask:0x1
    v_and_b32_dpp v33, v30, v6 quad_perm:[0,0,1,1] row_mask:0xf bank_mask:0x2
    v_and_b32_dpp v34, v31, v6 quad_perm:[0,0,1,1] row_mask:0xf bank_mask:0x4
    v_and_b32_dpp v35, v28, v6 quad_perm:[0,0,1,1] row_mask:0xf bank_mask:0x8
    s_waitcnt vmcnt(1)
    s_nop 0
    v_mfma_f32_16x16x32_bf16 v[16:19], v[32:35], v[80:83], v[16:19]
    v_and_b32_dpp v36, v29, v6 quad_perm:[2,2,3,3] row_mask:0xf bank_mask:0x1
    v_and_b32_dpp v37, v30, v6 quad_perm:[2,2,3,3] row_mask:0xf bank_mask:0x2
    v_and_b32_dpp v38, v31, v6 quad_perm:[2,2,3,3] row_mask:0xf bank_mask:0x4
    v_and_b32_dpp v39, v28, v6 quad_perm:[2,2,3,3] row_mask:0xf bank_mask:0x8
    s_waitcnt vmcnt(0)
    s_nop 0
    v_mfma_f32_16x16x32_bf16 v[16:19], v[36:39], v[84:87], v[16:19]
    s_branch L_drained
L_drain:
    s_waitcnt vmcnt(7)
    v_mfma_f32_16x16x32_bf16 v[40:43], v[56:59], v[20:23], 0
    s_waitcnt vmcnt(6)
    v_mfma_f32_16x16x32_bf16 v[40:43], v[60:63], v[24:27], v[40:43]
    s_waitcnt vmcnt(5)
    v_mfma_f32_16x16x32_bf16 v[44:47], v[64:67], v[20:23], 0
    s_waitcnt vmcnt(4)
    v_mfma_f32_16x16x32_bf16 v[44:47], v[68:71], v[24:27], v[44:47]
    s_nop 3
    v_add_f32_dpp v40, v41, v40 row_ror:12 row_mask:0xf bank_mask:0xf
    s_nop 2
    v_add_f32_dpp v45, v46, v45 row_ror:12 row_mask:0xf bank_mask:0xf
    v_add_f32_dpp v40, v42, v40 row_ror:8 row_mask:0xf bank_mask:0xf
    s_nop 0
    v_add_f32_dpp v45, v47, v45 row_ror:8 row_mask:0xf bank_mask:0xf
    v_add_f32_dpp v40, v43, v40 row_ror:4 row_mask:0xf bank_mask:0xf
    s_nop 0
    v_add_f32_dpp v45, v44, v45 row_ror:4 row_mask:0xf bank_mask:0xf
    v_cndmask_b32 v9, v40, v45, s[68:69]
    v_cndmask_b32 v9, v9, v3, s[72:73]
    v_cvt_pk_bf16_f32 v9, v9, v9
    v_lshlrev_b32 v9, 16, v9
    v_mul_f32 v9, s76, v9
    v_cvt_pk_bf16_f32 v9, v9, v9
    v_lshlrev_b32 v9, 16, v9
    v_cmp_gt_f32 vcc, v9, v7
    s_cbranch_vccnz L_rarex
L_contx:
    v_sub_f32 v10, v9, v7
    v_mul_f32 v10, s77, v10
    v_exp_f32 v10, v10
    s_nop 0
    v_cvt_pk_bf16_f32 v28, v10, v10
    v_add_f32 v8, v8, v10
    s_nop 0
    v_mov_b32_dpp v29, v28 row_ror:4 row_mask:0xf bank_mask:0xf
    v_mov_b32_dpp v30, v28 row_ror:8 row_mask:0xf bank_mask:0xf
    v_mov_b32_dpp v31, v28 row_ror:12 row_mask:0xf bank_mask:0xf
    v_add_f32_dpp v8, v8, v8 quad_perm:[2,3,0,1] row_mask:0xf bank_mask:0xf
    s_nop 1
    v_add_f32_dpp v8, v8, v8 row_ror:4 row_mask:0xf bank_mask:0xf
    s_nop 1
    v_add_f32_dpp v8, v8, v8 row_ror:8 row_mask:0xf bank_mask:0xf
    v_mov_b32 v10, v8
    s_nop 1
    v_permlane16_swap_b32 v8, v10
    v_add_f32 v8, v8, v10
    v_mov_b32 v10, v8
    s_nop 1
    v_permlane32_swap_b32 v8, v10
    v_add_f32 v8, v8, v10
    s_lshl_b32 s64, s3, 4
    s_add_u32 s64, s64, 130720
    v_lshl_add_u32 v9, v1, 3, s64
    v_mov_b32 v40, v7
    v_mov_b32 v41, v8
    s_mov_b64 exec, 3
    ds_write_b64 v9, v[40:41]
    s_mov_b64 exec, -1
    v_lshrrev_b32 v9, 5, v1
    v_lshlrev_b32 v15, 3, v9
    v_add_u32 v9, 130720, v15
    v_add_u32 v10, 133120, v4
    s_lshl_b32 s64, s2, 10
    s_add_u32 s64, s64, 131072
    s_lshl_b32 s65, s2, 7
    s_add_u32 s65, s65, 65536
    s_mov_b64 s[84:85], -1
    s_mov_b64 s[86:87], -1
    s_mov_b64 s[14:15], -1
    s_mov_b64 s[24:25], -1
    v_and_b32_dpp v32, v28, v6 quad_perm:[0,0,1,1] row_mask:0xf bank_mask:0x1
    v_and_b32_dpp v33, v29, v6 quad_perm:[0,0,1,1] row_mask:0xf bank_mask:0x2
    v_and_b32_dpp v34, v30, v6 quad_perm:[0,0,1,1] row_mask:0xf bank_mask:0x4
    v_and_b32_dpp v35, v31, v6 quad_perm:[0,0,1,1] row_mask:0xf bank_mask:0x8
    s_waitcnt vmcnt(3)
    s_nop 0
    v_mfma_f32_16x16x32_bf16 v[16:19], v[32:35], v[72:75], v[16:19]
    v_and_b32_dpp v36, v28, v6 quad_perm:[2,2,3,3] row_mask:0xf bank_mask:0x1
    v_and_b32_dpp v37, v29, v6 quad_perm:[2,2,3,3] row_mask:0xf bank_mask:0x2
    v_and_b32_dpp v38, v30, v6 quad_perm:[2,2,3,3] row_mask:0xf bank_mask:0x4
    v_and_b32_dpp v39, v31, v6 quad_perm:[2,2,3,3] row_mask:0xf bank_mask:0x8
    s_waitcnt vmcnt(2)
    s_nop 0
    v_mfma_f32_16x16x32_bf16 v[16:19], v[36:39], v[76:79], v[16:19]
    v_and_b32_dpp v32, v31, v6 quad_perm:[0,0,1,1] row_mask:0xf bank_mask:0x1
    v_and_b32_dpp v33, v28, v6 quad_perm:[0,0,1,1] row_mask:0xf bank_mask:0x2
    v_and_b32_dpp v34, v29, v6 quad_perm:[0,0,1,1] row_mask:0xf bank_mask:0x4
    v_and_b32_dpp v35, v30, v6 quad_perm:[0,0,1,1] row_mask:0xf bank_mask:0x8
    s_waitcnt vmcnt(1)
    s_nop 0
    v_mfma_f32_16x16x32_bf16 v[16:19], v[32:35], v[80:83], v[16:19]
    v_and_b32_dpp v36, v31, v6 quad_perm:[2,2,3,3] row_mask:0xf bank_mask:0x1
    v_and_b32_dpp v37, v28, v6 quad_perm:[2,2,3,3] row_mask:0xf bank_mask:0x2
    v_and_b32_dpp v38, v29, v6 quad_perm:[2,2,3,3] row_mask:0xf bank_mask:0x4
    v_and_b32_dpp v39, v30, v6 quad_perm:[2,2,3,3] row_mask:0xf bank_mask:0x8
    s_waitcnt vmcnt(0)
    s_nop 0
    v_mfma_f32_16x16x32_bf16 v[16:19], v[36:39], v[84:87], v[16:19]
L_drained:
    s_nop 7
    ds_write_b64 v5, v[16:17]
    ds_write_b64 v5, v[18:19] offset:512
    s_waitcnt lgkmcnt(0)
    s_barrier
    s_cmp_lg_u32 s3, 0
    s_cbranch_scc1 L_roles
    ds_read_b64 v[40:41], v9 offset:0
    ds_read_b64 v[42:43], v9 offset:16
    ds_read_b64 v[44:45], v9 offset:32
    ds_read_b64 v[46:47], v9 offset:48
    ds_read_b128 v[56:59], v10 offset:0
    ds_read_b128 v[60:63], v10 offset:3584
    ds_read_b128 v[64:67], v10 offset:7168
    ds_read_b128 v[68:71], v10 offset:10752
    s_waitcnt lgkmcnt(4)
    v_max_f32 v48, v40, v42
    v_max3_f32 v48, v48, v44, v46
    v_sub_f32 v40, v40, v48
    v_sub_f32 v42, v42, v48
    v_sub_f32 v44, v44, v48
    v_sub_f32 v46, v46, v48
    v_mul_f32 v40, s77, v40
    v_mul_f32 v42, s77, v42
    v_mul_f32 v44, s77, v44
    v_mul_f32 v46, s77, v46
    v_exp_f32 v40, v40
    v_exp_f32 v42, v42
    v_exp_f32 v44, v44
    v_exp_f32 v46, v46
    v_mul_f32 v49, v40, v41
    v_fmac_f32 v49, v42, v43
    v_fmac_f32 v49, v44, v45
    v_fmac_f32 v49, v46, v47
    s_waitcnt lgkmcnt(0)
    v_pk_mul_f32 v[16:17], v[40:41], v[56:57] op_sel_hi:[0,1]
    v_pk_mul_f32 v[18:19], v[40:41], v[58:59] op_sel_hi:[0,1]
    v_pk_fma_f32 v[16:17], v[42:43], v[60:61], v[16:17] op_sel_hi:[0,1,1]
    v_pk_fma_f32 v[18:19], v[42:43], v[62:63], v[18:19] op_sel_hi:[0,1,1]
    v_pk_fma_f32 v[16:17], v[44:45], v[64:65], v[16:17] op_sel_hi:[0,1,1]
    v_pk_fma_f32 v[18:19], v[44:45], v[66:67], v[18:19] op_sel_hi:[0,1,1]
    v_pk_fma_f32 v[16:17], v[46:47], v[68:69], v[16:17] op_sel_hi:[0,1,1]
    v_pk_fma_f32 v[18:19], v[46:47], v[70:71], v[18:19] op_sel_hi:[0,1,1]
    buffer_store_dwordx4 v[16:19], v4, s[36:39], s64 offen sc1
    s_mov_b32 exec_lo, 1
    s_mov_b32 exec_hi, 1
    buffer_store_dwordx2 v[48:49], v15, s[36:39], s65 offen sc1
    s_mov_b64 exec, -1
L_roles:
    s_cmp_eq_u32 s54, 0
    s_cbranch_scc1 L_ffn
    s_cmp_eq_u32 s54, 2
    s_cbranch_scc1 L_fin
L_h1poll:
    buffer_load_dwordx2 v[40:41], v237, s[36:39], s0 offen sc1
    s_mov_b64 exec, s[84:85]
    s_cbranch_execz L_h1s0
    buffer_load_dwordx4 v[56:59], v238, s[36:39], s1 offen offset:0 sc1
    buffer_load_dwordx4 v[60:63], v238, s[36:39], s1 offen offset:256 sc1
L_h1s0:
    s_mov_b64 exec, s[86:87]
    s_cbranch_execz L_h1s1
    buffer_load_dwordx4 v[64:67], v239, s[36:39], s1 offen offset:0 sc1
    buffer_load_dwordx4 v[68:71], v239, s[36:39], s1 offen offset:256 sc1
L_h1s1:
    s_mov_b64 exec, s[14:15]
    s_cbranch_execz L_h1s2
    buffer_load_dwordx4 v[72:75], v240, s[36:39], s1 offen offset:0 sc1
    buffer_load_dwordx4 v[76:79], v240, s[36:39], s1 offen offset:256 sc1
L_h1s2:
    s_mov_b64 exec, s[24:25]
    s_cbranch_execz L_h1s3
    buffer_load_dwordx4 v[80:83], v241, s[36:39], s1 offen offset:0 sc1
    buffer_load_dwordx4 v[84:87], v241, s[36:39], s1 offen offset:256 sc1
L_h1s3:
    s_mov_b64 exec, -1
    s_waitcnt vmcnt(0)
    v_max_u32 v10, v40, v41
    v_max_u32 v32, v56, v57
    v_max_u32 v33, v64, v65
    v_max_u32 v34, v72, v73
    v_max_u32 v35, v80, v81
    v_cmp_eq_u32 s[80:81], -1, v10
    v_max3_u32 v32, v32, v58, v59
    v_max3_u32 v33, v33, v66, v67
    v_max3_u32 v34, v34, v74, v75
    v_max3_u32 v35, v35, v82, v83
    v_max3_u32 v32, v32, v60, v61
    v_max3_u32 v33, v33, v68, v69
    v_max3_u32 v34, v34, v76, v77
    v_max3_u32 v35, v35, v84, v85
    v_max3_u32 v32, v32, v62, v63
    v_max3_u32 v33, v33, v70, v71
    v_max3_u32 v34, v34, v78, v79
    v_max3_u32 v35, v35, v86, v87
    v_cmp_eq_u32 s[84:85], -1, v32
    v_cmp_eq_u32 s[86:87], -1, v33
    v_cmp_eq_u32 s[14:15], -1, v34
    v_cmp_eq_u32 s[24:25], -1, v35
    v_mov_b32 v10, v40
    s_or_b64 vcc, s[80:81], s[84:85]
    s_or_b64 vcc, vcc, s[86:87]
    s_or_b64 vcc, vcc, s[14:15]
    s_or_b64 vcc, vcc, s[24:25]
    s_cbranch_vccz L_h1ok
L_h1gate:
    s_and_b32 s64, s80, 0xffff
    s_bcnt1_i32_b32 s64, s64
    s_sub_u32 s63, s63, 1
    s_cmp_eq_u32 s63, 0
    s_cbranch_scc1 L_end
    s_cmp_le_u32 s64, 15
    s_cbranch_scc1 L_h1poll
    buffer_load_dwordx2 v[40:41], v237, s[36:39], s0 offen sc1
    s_waitcnt vmcnt(0)
    v_cmp_eq_u32 s[80:81], -1, v41
    s_branch L_h1gate
L_h1ok:
    v_max_f32_dpp v10, v10, v10 row_ror:8 row_mask:0xf bank_mask:0xf
    s_nop 1
    v_max_f32_dpp v10, v10, v10 row_ror:4 row_mask:0xf bank_mask:0xf
    s_nop 1
    v_max_f32_dpp v10, v10, v10 row_ror:2 row_mask:0xf bank_mask:0xf
    s_nop 1
    v_max_f32_dpp v10, v10, v10 row_ror:1 row_mask:0xf bank_mask:0xf
    v_sub_f32 v10, v40, v10
    v_mul_f32 v10, s77, v10
    v_exp_f32 v10, v10
    s_nop 0
    v_mul_f32 v11, v10, v41
    v_mov_b32_dpp v32, v10 row_newbcast:0 row_mask:0xf bank_mask:0xf
    v_mov_b32_dpp v34, v10 row_newbcast:4 row_mask:0xf bank_mask:0xf
    v_mov_b32_dpp v36, v10 row_newbcast:8 row_mask:0xf bank_mask:0xf
    v_mov_b32_dpp v38, v10 row_newbcast:12 row_mask:0xf bank_mask:0xf
    v_add_f32_dpp v11, v11, v11 row_ror:8 row_mask:0xf bank_mask:0xf
    v_pk_mul_f32 v[16:17], v[32:33], v[56:57] op_sel_hi:[0,1]
    v_pk_mul_f32 v[18:19], v[32:33], v[58:59] op_sel_hi:[0,1]
    v_pk_mul_f32 v[20:21], v[32:33], v[60:61] op_sel_hi:[0,1]
    v_pk_mul_f32 v[22:23], v[32:33], v[62:63] op_sel_hi:[0,1]
    v_add_f32_dpp v11, v11, v11 row_ror:4 row_mask:0xf bank_mask:0xf
    v_pk_fma_f32 v[16:17], v[34:35], v[64:65], v[16:17] op_sel_hi:[0,1,1]
    v_pk_fma_f32 v[18:19], v[34:35], v[66:67], v[18:19] op_sel_hi:[0,1,1]
    v_pk_fma_f32 v[20:21], v[34:35], v[68:69], v[20:21] op_sel_hi:[0,1,1]
    v_pk_fma_f32 v[22:23], v[34:35], v[70:71], v[22:23] op_sel_hi:[0,1,1]
    v_add_f32_dpp v11, v11, v11 row_ror:2 row_mask:0xf bank_mask:0xf
    v_pk_fma_f32 v[16:17], v[36:37], v[72:73], v[16:17] op_sel_hi:[0,1,1]
    v_pk_fma_f32 v[18:19], v[36:37], v[74:75], v[18:19] op_sel_hi:[0,1,1]
    v_pk_fma_f32 v[20:21], v[36:37], v[76:77], v[20:21] op_sel_hi:[0,1,1]
    v_pk_fma_f32 v[22:23], v[36:37], v[78:79], v[22:23] op_sel_hi:[0,1,1]
    v_add_f32_dpp v11, v11, v11 row_ror:1 row_mask:0xf bank_mask:0xf
    v_pk_fma_f32 v[16:17], v[38:39], v[80:81], v[16:17] op_sel_hi:[0,1,1]
    v_pk_fma_f32 v[18:19], v[38:39], v[82:83], v[18:19] op_sel_hi:[0,1,1]
    v_pk_fma_f32 v[20:21], v[38:39], v[84:85], v[20:21] op_sel_hi:[0,1,1]
    v_pk_fma_f32 v[22:23], v[38:39], v[86:87], v[22:23] op_sel_hi:[0,1,1]
    v_rcp_f32 v11, v11
    v_permlane32_swap_b32 v16, v17
    v_permlane32_swap_b32 v18, v19
    v_permlane32_swap_b32 v20, v21
    v_permlane32_swap_b32 v22, v23
    v_add_f32 v16, v16, v17
    v_add_f32 v18, v18, v19
    v_add_f32 v20, v20, v21
    v_add_f32 v22, v22, v23
    v_permlane16_swap_b32 v16, v18
    s_nop 0
    v_permlane16_swap_b32 v20, v22
    v_add_f32 v16, v16, v18
    v_add_f32 v20, v20, v22
    v_mul_f32 v16, v16, v11
    v_mul_f32 v20, v20, v11
    v_cvt_pk_bf16_f32 v10, v16, v20
    ds_write_b16 v242, v10
    ds_write_b16_d16_hi v242, v10 offset:128
    s_waitcnt lgkmcnt(0)
    s_barrier
    ds_read_b128 v[16:19], v244 offset:0
    ds_read_b128 v[20:23], v244 offset:64
    ds_read_b128 v[24:27], v244 offset:128
    ds_read_b128 v[28:31], v244 offset:192
    ds_read_b128 v[32:35], v244 offset:256
    ds_read_b128 v[36:39], v244 offset:320
    ds_read_b128 v[40:43], v244 offset:384
    ds_read_b128 v[44:47], v244 offset:448
    ds_read_b128 v[48:51], v244 offset:512
    ds_read_b128 v[52:55], v244 offset:576
    ds_read_b128 v[56:59], v244 offset:640
    ds_read_b128 v[60:63], v244 offset:704
    ds_read_b128 v[64:67], v244 offset:768
    ds_read_b128 v[68:71], v244 offset:832
    s_waitcnt lgkmcnt(13)
    v_mfma_f32_16x16x32_bf16 v[80:83], v[88:91], v[16:19], 0
    ds_read_b128 v[72:75], v244 offset:896
    s_waitcnt lgkmcnt(13)
    v_mfma_f32_16x16x32_bf16 v[80:83], v[92:95], v[20:23], v[80:83]
    ds_read_b128 v[76:79], v244 offset:960
    s_waitcnt lgkmcnt(13)
    v_mfma_f32_16x16x32_bf16 v[80:83], v[96:99], v[24:27], v[80:83]
    s_waitcnt lgkmcnt(12)
    v_mfma_f32_16x16x32_bf16 v[80:83], v[100:103], v[28:31], v[80:83]
    s_waitcnt lgkmcnt(11)
    v_mfma_f32_16x16x32_bf16 v[80:83], v[104:107], v[32:35], v[80:83]
    s_waitcnt lgkmcnt(10)
    v_mfma_f32_16x16x32_bf16 v[80:83], v[108:111], v[36:39], v[80:83]
    s_waitcnt lgkmcnt(9)
    v_mfma_f32_16x16x32_bf16 v[80:83], v[112:115], v[40:43], v[80:83]
    s_waitcnt lgkmcnt(8)
    v_mfma_f32_16x16x32_bf16 v[80:83], v[116:119], v[44:47], v[80:83]
    s_waitcnt lgkmcnt(7)
    v_mfma_f32_16x16x32_bf16 v[80:83], v[120:123], v[48:51], v[80:83]
    s_waitcnt lgkmcnt(6)
    v_mfma_f32_16x16x32_bf16 v[80:83], v[124:127], v[52:55], v[80:83]
    s_waitcnt lgkmcnt(5)
    v_mfma_f32_16x16x32_bf16 v[80:83], v[128:131], v[56:59], v[80:83]
    s_waitcnt lgkmcnt(4)
    v_mfma_f32_16x16x32_bf16 v[80:83], v[132:135], v[60:63], v[80:83]
    s_waitcnt lgkmcnt(3)
    v_mfma_f32_16x16x32_bf16 v[80:83], v[136:139], v[64:67], v[80:83]
    s_waitcnt lgkmcnt(2)
    v_mfma_f32_16x16x32_bf16 v[80:83], v[140:143], v[68:71], v[80:83]
    s_waitcnt lgkmcnt(1)
    v_mfma_f32_16x16x32_bf16 v[80:83], v[144:147], v[72:75], v[80:83]
    s_waitcnt lgkmcnt(0)
    v_mfma_f32_16x16x32_bf16 v[80:83], v[148:151], v[76:79], v[80:83]
    s_mov_b64 exec, s[82:83]
    s_nop 6
    buffer_store_dwordx4 v[80:83], v243, s[36:39], s98 offen sc1
    s_mov_b64 exec, -1
    s_branch L_fin
L_ffn:
    v_lshlrev_b32 v232, 16, v232
    v_lshlrev_b32 v233, 16, v233
    v_lshlrev_b32 v234, 16, v234
    v_mov_b32 v14, 0x3f803f80
    ds_write_b32 v245, v14 offset:0
    ds_write_b32 v245, v14 offset:256
    ds_write_b32 v245, v14 offset:512
    ds_write_b32 v245, v14 offset:768
    ds_write_b32 v245, v14 offset:896
    s_mul_i32 s64, s3, 1296
    s_add_u32 s64, s64, s55
    s_lshl_b32 s64, s64, 6
    s_add_u32 s59, s64, 458752
    s_lshl_b32 s64, s3, 9
    s_add_u32 s64, s64, 131072
    v_mov_b32 v14, 0
    v_lshl_add_u32 v15, v1, 2, s64
    ds_write_b32 v15, v14 offset:0
    ds_write_b32 v15, v14 offset:256
    s_add_u32 s64, s64, 240
    v_lshl_add_u32 v241, v1, 1, s64
    v_and_b32 v14, 15, v1
    v_lshlrev_b32 v15, 4, v14
    v_sub_u32 v15, 131312, v15
    v_lshl_add_u32 v242, v243, 5, v15
    v_mul_u32_u24 v14, 9216, v14
    v_add_u32 v246, v14, v243
    s_mov_b32 s71, 0x3d372713
    s_lshl_b32 s64, s3, 11
    s_add_u32 s64, s64, 393216
    s_add_u32 s65, s64, 8192
    s_mov_b32 s66, 409600
    s_mov_b32 s62, 0
    v_mov_b32 v13, 130784
    s_cmp_lg_u32 s3, 0
    s_cbranch_scc1 L_h2wait
    v_lshlrev_b32 v9, 8, v1
    s_lshl_b32 s67, s22, 11
    s_add_u32 s67, s67, 393216
    v_and_b32 v9, 0x7ff, v9
L_h2gate:
    buffer_load_dword v10, v9, s[36:39], s67 offen sc1
    ds_read_b32 v11, v13 offset:12
    s_waitcnt vmcnt(0) lgkmcnt(0)
    v_cmp_eq_u32 vcc, -1, v10
    v_readfirstlane_b32 s70, v11
    s_cbranch_vccz L_h2go
    s_cmp_le_u32 s70, s62
    s_cbranch_scc1 L_h2g2
    s_cmp_eq_u32 s62, 0
    s_cbranch_scc1 L_h2g2a
    ds_read_b64_tr_b16 v[160:161], v248 offset:0
    ds_read_b64_tr_b16 v[162:163], v248 offset:4608
    ds_read_b64_tr_b16 v[164:165], v249 offset:0
    ds_read_b64_tr_b16 v[166:167], v249 offset:4608
    ds_read_b64_tr_b16 v[168:169], v250 offset:0
    ds_read_b64_tr_b16 v[170:171], v250 offset:4608
    ds_read_b64_tr_b16 v[172:173], v251 offset:0
    ds_read_b64_tr_b16 v[174:175], v251 offset:4608
    ds_read_b64_tr_b16 v[176:177], v248 offset:128
    ds_read_b64_tr_b16 v[178:179], v248 offset:4736
    ds_read_b64_tr_b16 v[180:181], v249 offset:128
    ds_read_b64_tr_b16 v[182:183], v249 offset:4736
    ds_read_b64_tr_b16 v[184:185], v250 offset:128
    ds_read_b64_tr_b16 v[186:187], v250 offset:4736
    ds_read_b64_tr_b16 v[188:189], v251 offset:128
    ds_read_b64_tr_b16 v[190:191], v251 offset:4736
    ds_read_b64_tr_b16 v[192:193], v248 offset:256
    ds_read_b64_tr_b16 v[194:195], v248 offset:4864
    s_mov_b32 s62, 2
    s_branch L_h2g2
L_h2g2a:
    ds_read_b64_tr_b16 v[88:89], v244 offset:0
    ds_read_b64_tr_b16 v[90:91], v244 offset:256
    ds_read_b64_tr_b16 v[92:93], v244 offset:2048
    ds_read_b64_tr_b16 v[94:95], v244 offset:2304
    ds_read_b64_tr_b16 v[96:97], v244 offset:4096
    ds_read_b64_tr_b16 v[98:99], v244 offset:4352
    ds_read_b64_tr_b16 v[100:101], v244 offset:6144
    ds_read_b64_tr_b16 v[102:103], v244 offset:6400
    ds_read_b64_tr_b16 v[104:105], v244 offset:8192
    ds_read_b64_tr_b16 v[106:107], v244 offset:8448
    ds_read_b64_tr_b16 v[108:109], v244 offset:10240
    ds_read_b64_tr_b16 v[110:111], v244 offset:10496
    ds_read_b64_tr_b16 v[112:113], v244 offset:12288
    ds_read_b64_tr_b16 v[114:115], v244 offset:12544
    ds_read_b64_tr_b16 v[116:117], v244 offset:14336
    ds_read_b64_tr_b16 v[118:119], v244 offset:14592
    ds_read_b64_tr_b16 v[120:121], v244 offset:16384
    ds_read_b64_tr_b16 v[122:123], v244 offset:16640
    ds_read_b64_tr_b16 v[124:125], v244 offset:18432
    ds_read_b64_tr_b16 v[126:127], v244 offset:18688
    ds_read_b64_tr_b16 v[128:129], v244 offset:20480
    ds_read_b64_tr_b16 v[130:131], v244 offset:20736
    ds_read_b64_tr_b16 v[132:133], v244 offset:22528
    ds_read_b64_tr_b16 v[134:135], v244 offset:22784
    ds_read_b64_tr_b16 v[136:137], v244 offset:24576
    ds_read_b64_tr_b16 v[138:139], v244 offset:24832
    ds_read_b64_tr_b16 v[140:141], v244 offset:26624
    ds_read_b64_tr_b16 v[142:143], v244 offset:26880
    ds_read_b64_tr_b16 v[144:145], v244 offset:28672
    ds_read_b64_tr_b16 v[146:147], v244 offset:28928
    ds_read_b64_tr_b16 v[148:149], v244 offset:30720
    ds_read_b64_tr_b16 v[150:151], v244 offset:30976
    ds_read_b64_tr_b16 v[152:153], v244 offset:32768
    ds_read_b64_tr_b16 v[154:155], v244 offset:33024
    ds_read_b64_tr_b16 v[156:157], v244 offset:34816
    ds_read_b64_tr_b16 v[158:159], v244 offset:35072
    s_mov_b32 s62, 1
L_h2g2:
    s_sleep 5
    s_sub_u32 s63, s63, 1
    s_cmp_eq_u32 s63, 0
    s_cbranch_scc1 L_end
    s_branch L_h2gate
L_h2go:
    v_mov_b32 v14, 1
    ds_write_b32 v13, v14 offset:8
L_h2Ba:
    s_mov_b64 exec, s[84:85]
    s_cbranch_execz L_h2la0
    buffer_load_dwordx4 v[32:35], v4, s[36:39], s64 offen offset:0 sc1
    buffer_load_dwordx4 v[40:43], v4, s[36:39], s65 offen offset:0 sc1
    buffer_load_dwordx4 v[48:51], v4, s[36:39], s66 offen offset:0 sc1
L_h2la0:
    s_mov_b64 exec, s[86:87]
    s_cbranch_execz L_h2la1
    buffer_load_dwordx4 v[36:39], v4, s[36:39], s64 offen offset:1024 sc1
    buffer_load_dwordx4 v[44:47], v4, s[36:39], s65 offen offset:1024 sc1
    buffer_load_dwordx4 v[52:55], v4, s[36:39], s66 offen offset:1024 sc1
L_h2la1:
    s_mov_b64 exec, -1
    s_waitcnt vmcnt(0)
    v_max_u32 v252, v32, v33
    v_max_u32 v253, v36, v37
    v_max3_u32 v252, v252, v34, v35
    v_max3_u32 v253, v253, v38, v39
    v_max3_u32 v252, v252, v40, v41
    v_max3_u32 v253, v253, v44, v45
    v_max3_u32 v252, v252, v42, v43
    v_max3_u32 v253, v253, v46, v47
    v_max3_u32 v252, v252, v48, v49
    v_max3_u32 v253, v253, v52, v53
    v_max3_u32 v252, v252, v50, v51
    v_max3_u32 v253, v253, v54, v55
    v_cmp_eq_u32 s[84:85], -1, v252
    v_cmp_eq_u32 s[86:87], -1, v253
    v_pk_add_f32 v[16:17], v[32:33], v[36:37]
    v_pk_add_f32 v[18:19], v[34:35], v[38:39]
    v_pk_add_f32 v[20:21], v[40:41], v[44:45]
    v_pk_add_f32 v[22:23], v[42:43], v[46:47]
    v_pk_add_f32 v[24:25], v[48:49], v[52:53]
    v_pk_add_f32 v[26:27], v[50:51], v[54:55]
    s_or_b64 vcc, s[84:85], s[86:87]
    s_cbranch_vccz L_h2oka
    s_sub_u32 s63, s63, 1
    s_cmp_eq_u32 s63, 0
    s_cbranch_scc1 L_end
    s_branch L_h2Ba
L_h2oka:
    v_permlane32_swap_b32 v16, v17
    v_permlane32_swap_b32 v18, v19
    v_permlane32_swap_b32 v20, v21
    v_permlane32_swap_b32 v22, v23
    v_permlane32_swap_b32 v24, v25
    v_permlane32_swap_b32 v26, v27
    v_add_f32 v16, v16, v17
    v_add_f32 v18, v18, v19
    v_add_f32 v20, v20, v21
    v_add_f32 v22, v22, v23
    v_add_f32 v24, v24, v25
    v_add_f32 v26, v26, v27
    v_permlane16_swap_b32 v16, v18
    v_permlane16_swap_b32 v20, v22
    v_permlane16_swap_b32 v24, v26
    v_add_f32 v16, v16, v18
    v_add_f32 v20, v20, v22
    v_add_f32 v24, v24, v26
    v_add_f32 v16, v16, v232
    v_add_f32 v20, v20, v233
    v_add_f32 v24, v24, v234
    v_cvt_pk_bf16_f32 v16, v16, v16
    v_cvt_pk_bf16_f32 v20, v20, v20
    v_cvt_pk_bf16_f32 v24, v24, v24
    ds_write_b16 v237, v16 offset:0
    ds_write_b16 v237, v20 offset:512
    ds_write_b16 v237, v24 offset:1024
    s_branch L_h2late
L_h2wait:
    ds_read_b64 v[252:253], v13 offset:8
    s_waitcnt lgkmcnt(0)
    v_readfirstlane_b32 s67, v252
    v_readfirstlane_b32 s70, v253
    s_cmp_eq_u32 s67, 1
    s_cbranch_scc1 L_h2Bb
    s_cmp_le_u32 s70, s62
    s_cbranch_scc1 L_h2w2
    s_cmp_eq_u32 s62, 0
    s_cbranch_scc1 L_h2w2a
    ds_read_b64_tr_b16 v[160:161], v248 offset:0
    ds_read_b64_tr_b16 v[162:163], v248 offset:4608
    ds_read_b64_tr_b16 v[164:165], v249 offset:0
    ds_read_b64_tr_b16 v[166:167], v249 offset:4608
    ds_read_b64_tr_b16 v[168:169], v250 offset:0
    ds_read_b64_tr_b16 v[170:171], v250 offset:4608
    ds_read_b64_tr_b16 v[172:173], v251 offset:0
    ds_read_b64_tr_b16 v[174:175], v251 offset:4608
    ds_read_b64_tr_b16 v[176:177], v248 offset:128
    ds_read_b64_tr_b16 v[178:179], v248 offset:4736
    ds_read_b64_tr_b16 v[180:181], v249 offset:128
    ds_read_b64_tr_b16 v[182:183], v249 offset:4736
    ds_read_b64_tr_b16 v[184:185], v250 offset:128
    ds_read_b64_tr_b16 v[186:187], v250 offset:4736
    ds_read_b64_tr_b16 v[188:189], v251 offset:128
    ds_read_b64_tr_b16 v[190:191], v251 offset:4736
    ds_read_b64_tr_b16 v[192:193], v248 offset:256
    ds_read_b64_tr_b16 v[194:195], v248 offset:4864
    s_mov_b32 s62, 2
    s_branch L_h2w2
L_h2w2a:
    ds_read_b64_tr_b16 v[88:89], v244 offset:0
    ds_read_b64_tr_b16 v[90:91], v244 offset:256
    ds_read_b64_tr_b16 v[92:93], v244 offset:2048
    ds_read_b64_tr_b16 v[94:95], v244 offset:2304
    ds_read_b64_tr_b16 v[96:97], v244 offset:4096
    ds_read_b64_tr_b16 v[98:99], v244 offset:4352
    ds_read_b64_tr_b16 v[100:101], v244 offset:6144
    ds_read_b64_tr_b16 v[102:103], v244 offset:6400
    ds_read_b64_tr_b16 v[104:105], v244 offset:8192
    ds_read_b64_tr_b16 v[106:107], v244 offset:8448
    ds_read_b64_tr_b16 v[108:109], v244 offset:10240
    ds_read_b64_tr_b16 v[110:111], v244 offset:10496
    ds_read_b64_tr_b16 v[112:113], v244 offset:12288
    ds_read_b64_tr_b16 v[114:115], v244 offset:12544
    ds_read_b64_tr_b16 v[116:117], v244 offset:14336
    ds_read_b64_tr_b16 v[118:119], v244 offset:14592
    ds_read_b64_tr_b16 v[120:121], v244 offset:16384
    ds_read_b64_tr_b16 v[122:123], v244 offset:16640
    ds_read_b64_tr_b16 v[124:125], v244 offset:18432
    ds_read_b64_tr_b16 v[126:127], v244 offset:18688
    ds_read_b64_tr_b16 v[128:129], v244 offset:20480
    ds_read_b64_tr_b16 v[130:131], v244 offset:20736
    ds_read_b64_tr_b16 v[132:133], v244 offset:22528
    ds_read_b64_tr_b16 v[134:135], v244 offset:22784
    ds_read_b64_tr_b16 v[136:137], v244 offset:24576
    ds_read_b64_tr_b16 v[138:139], v244 offset:24832
    ds_read_b64_tr_b16 v[140:141], v244 offset:26624
    ds_read_b64_tr_b16 v[142:143], v244 offset:26880
    ds_read_b64_tr_b16 v[144:145], v244 offset:28672
    ds_read_b64_tr_b16 v[146:147], v244 offset:28928
    ds_read_b64_tr_b16 v[148:149], v244 offset:30720
    ds_read_b64_tr_b16 v[150:151], v244 offset:30976
    ds_read_b64_tr_b16 v[152:153], v244 offset:32768
    ds_read_b64_tr_b16 v[154:155], v244 offset:33024
    ds_read_b64_tr_b16 v[156:157], v244 offset:34816
    ds_read_b64_tr_b16 v[158:159], v244 offset:35072
    s_mov_b32 s62, 1
L_h2w2:
    s_sub_u32 s63, s63, 1
    s_cmp_eq_u32 s63, 0
    s_cbranch_scc1 L_end
    s_branch L_h2wait
L_h2Bb:
    s_mov_b64 exec, s[84:85]
    s_cbranch_execz L_h2lb0
    buffer_load_dwordx4 v[32:35], v4, s[36:39], s64 offen offset:0 sc1
    buffer_load_dwordx4 v[40:43], v4, s[36:39], s65 offen offset:0 sc1
L_h2lb0:
    s_mov_b64 exec, s[86:87]
    s_cbranch_execz L_h2lb1
    buffer_load_dwordx4 v[36:39], v4, s[36:39], s64 offen offset:1024 sc1
    buffer_load_dwordx4 v[44:47], v4, s[36:39], s65 offen offset:1024 sc1
L_h2lb1:
    s_mov_b64 exec, -1
    s_waitcnt vmcnt(0)
    v_max_u32 v252, v32, v33
    v_max_u32 v253, v36, v37
    v_max3_u32 v252, v252, v34, v35
    v_max3_u32 v253, v253, v38, v39
    v_max3_u32 v252, v252, v40, v41
    v_max3_u32 v253, v253, v44, v45
    v_max3_u32 v252, v252, v42, v43
    v_max3_u32 v253, v253, v46, v47
    v_cmp_eq_u32 s[84:85], -1, v252
    v_cmp_eq_u32 s[86:87], -1, v253
    v_pk_add_f32 v[16:17], v[32:33], v[36:37]
    v_pk_add_f32 v[18:19], v[34:35], v[38:39]
    v_pk_add_f32 v[20:21], v[40:41], v[44:45]
    v_pk_add_f32 v[22:23], v[42:43], v[46:47]
    s_or_b64 vcc, s[84:85], s[86:87]
    s_cbranch_vccz L_h2okb
    s_sub_u32 s63, s63, 1
    s_cmp_eq_u32 s63, 0
    s_cbranch_scc1 L_end
    s_branch L_h2Bb
L_h2okb:
    v_permlane32_swap_b32 v16, v17
    v_permlane32_swap_b32 v18, v19
    v_permlane32_swap_b32 v20, v21
    v_permlane32_swap_b32 v22, v23
    v_add_f32 v16, v16, v17
    v_add_f32 v18, v18, v19
    v_add_f32 v20, v20, v21
    v_add_f32 v22, v22, v23
    v_permlane16_swap_b32 v16, v18
    s_nop 0
    v_permlane16_swap_b32 v20, v22
    v_add_f32 v16, v16, v18
    v_add_f32 v20, v20, v22
    v_add_f32 v16, v16, v232
    v_add_f32 v20, v20, v233
    v_cvt_pk_bf16_f32 v16, v16, v16
    v_cvt_pk_bf16_f32 v20, v20, v20
    ds_write_b16 v237, v16 offset:0
    ds_write_b16 v237, v20 offset:512
L_h2late:
    s_cmp_eq_u32 s62, 2
    s_cbranch_scc1 L_h2red
    v_mov_b32 v9, 130784
L_lw2:
    ds_read_b32 v10, v9 offset:12
    s_waitcnt lgkmcnt(0)
    v_cmp_eq_u32 vcc, 2, v10
    s_cbranch_vccnz L_lw2ok
    s_sub_u32 s63, s63, 1
    s_cmp_eq_u32 s63, 0
    s_cbranch_scc1 L_end
    s_branch L_lw2
L_lw2ok:
    ds_read_b64_tr_b16 v[160:161], v248 offset:0
    ds_read_b64_tr_b16 v[162:163], v248 offset:4608
    ds_read_b64_tr_b16 v[164:165], v249 offset:0
    ds_read_b64_tr_b16 v[166:167], v249 offset:4608
    ds_read_b64_tr_b16 v[168:169], v250 offset:0
    ds_read_b64_tr_b16 v[170:171], v250 offset:4608
    ds_read_b64_tr_b16 v[172:173], v251 offset:0
    ds_read_b64_tr_b16 v[174:175], v251 offset:4608
    ds_read_b64_tr_b16 v[176:177], v248 offset:128
    ds_read_b64_tr_b16 v[178:179], v248 offset:4736
    ds_read_b64_tr_b16 v[180:181], v249 offset:128
    ds_read_b64_tr_b16 v[182:183], v249 offset:4736
    ds_read_b64_tr_b16 v[184:185], v250 offset:128
    ds_read_b64_tr_b16 v[186:187], v250 offset:4736
    ds_read_b64_tr_b16 v[188:189], v251 offset:128
    ds_read_b64_tr_b16 v[190:191], v251 offset:4736
    ds_read_b64_tr_b16 v[192:193], v248 offset:256
    ds_read_b64_tr_b16 v[194:195], v248 offset:4864
    s_cmp_eq_u32 s62, 1
    s_cbranch_scc1 L_h2red
    ds_read_b64_tr_b16 v[88:89], v244 offset:0
    ds_read_b64_tr_b16 v[90:91], v244 offset:256
    ds_read_b64_tr_b16 v[92:93], v244 offset:2048
    ds_read_b64_tr_b16 v[94:95], v244 offset:2304
    ds_read_b64_tr_b16 v[96:97], v244 offset:4096
    ds_read_b64_tr_b16 v[98:99], v244 offset:4352
    ds_read_b64_tr_b16 v[100:101], v244 offset:6144
    ds_read_b64_tr_b16 v[102:103], v244 offset:6400
    ds_read_b64_tr_b16 v[104:105], v244 offset:8192
    ds_read_b64_tr_b16 v[106:107], v244 offset:8448
    ds_read_b64_tr_b16 v[108:109], v244 offset:10240
    ds_read_b64_tr_b16 v[110:111], v244 offset:10496
    ds_read_b64_tr_b16 v[112:113], v244 offset:12288
    ds_read_b64_tr_b16 v[114:115], v244 offset:12544
    ds_read_b64_tr_b16 v[116:117], v244 offset:14336
    ds_read_b64_tr_b16 v[118:119], v244 offset:14592
    ds_read_b64_tr_b16 v[120:121], v244 offset:16384
    ds_read_b64_tr_b16 v[122:123], v244 offset:16640
    ds_read_b64_tr_b16 v[124:125], v244 offset:18432
    ds_read_b64_tr_b16 v[126:127], v244 offset:18688
    ds_read_b64_tr_b16 v[128:129], v244 offset:20480
    ds_read_b64_tr_b16 v[130:131], v244 offset:20736
    ds_read_b64_tr_b16 v[132:133], v244 offset:22528
    ds_read_b64_tr_b16 v[134:135], v244 offset:22784
    ds_read_b64_tr_b16 v[136:137], v244 offset:24576
    ds_read_b64_tr_b16 v[138:139], v244 offset:24832
    ds_read_b64_tr_b16 v[140:141], v244 offset:26624
    ds_read_b64_tr_b16 v[142:143], v244 offset:26880
    ds_read_b64_tr_b16 v[144:145], v244 offset:28672
    ds_read_b64_tr_b16 v[146:147], v244 offset:28928
    ds_read_b64_tr_b16 v[148:149], v244 offset:30720
    ds_read_b64_tr_b16 v[150:151], v244 offset:30976
    ds_read_b64_tr_b16 v[152:153], v244 offset:32768
    ds_read_b64_tr_b16 v[154:155], v244 offset:33024
    ds_read_b64_tr_b16 v[156:157], v244 offset:34816
    ds_read_b64_tr_b16 v[158:159], v244 offset:35072
L_h2red:
    s_waitcnt lgkmcnt(0)
    s_barrier
    ds_read_b128 v[196:199], v239
    ds_read_u16 v200, v240 offset:1024
    ds_read_b128 v[16:19], v238 offset:0
    ds_read_b128 v[20:23], v238 offset:64
    ds_read_b128 v[24:27], v238 offset:128
    ds_read_b128 v[28:31], v238 offset:192
    ds_read_b128 v[32:35], v238 offset:256
    ds_read_b128 v[36:39], v238 offset:320
    ds_read_b128 v[40:43], v238 offset:384
    ds_read_b128 v[44:47], v238 offset:448
    ds_read_b128 v[48:51], v238 offset:512
    ds_read_b128 v[52:55], v238 offset:576
    ds_read_b128 v[56:59], v238 offset:640
    ds_read_b128 v[60:63], v238 offset:704
    s_mov_b32 s67, 0x3f803f80
    s_mov_b32 s70, 0x3ae38e39
    s_waitcnt lgkmcnt(11)
    v_mfma_f32_16x16x32_bf16 v[204:207], v[16:19], v[88:91], 0
    ds_read_b128 v[64:67], v238 offset:768
    v_dot2_f32_bf16 v9, v196, s67, 0
    s_waitcnt lgkmcnt(11)
    v_mfma_f32_16x16x32_bf16 v[204:207], v[20:23], v[92:95], v[204:207]
    ds_read_b128 v[68:71], v238 offset:832
    v_dot2_f32_bf16 v11, v196, v196, 0
    s_waitcnt lgkmcnt(11)
    v_mfma_f32_16x16x32_bf16 v[204:207], v[24:27], v[96:99], v[204:207]
    ds_read_b128 v[72:75], v238 offset:896
    v_dot2_f32_bf16 v9, v197, s67, v9
    s_waitcnt lgkmcnt(11)
    v_mfma_f32_16x16x32_bf16 v[204:207], v[28:31], v[100:103], v[204:207]
    ds_read_b128 v[76:79], v238 offset:960
    v_dot2_f32_bf16 v11, v197, v197, v11
    s_waitcnt lgkmcnt(11)
    v_mfma_f32_16x16x32_bf16 v[204:207], v[32:35], v[104:107], v[204:207]
    ds_read_b128 v[80:83], v238 offset:1024
    v_dot2_f32_bf16 v9, v198, s67, v9
    s_waitcnt lgkmcnt(11)
    v_mfma_f32_16x16x32_bf16 v[204:207], v[36:39], v[108:111], v[204:207]
    ds_read_b128 v[84:87], v238 offset:1088
    v_dot2_f32_bf16 v11, v198, v198, v11
    s_waitcnt lgkmcnt(11)
    v_mfma_f32_16x16x32_bf16 v[204:207], v[40:43], v[112:115], v[204:207]
    v_dot2_f32_bf16 v9, v199, s67, v9
    v_dot2_f32_bf16 v11, v199, v199, v11
    s_waitcnt lgkmcnt(10)
    v_mfma_f32_16x16x32_bf16 v[204:207], v[44:47], v[116:119], v[204:207]
    v_dot2_f32_bf16 v9, v200, s67, v9
    v_dot2_f32_bf16 v11, v200, v200, v11
    s_waitcnt lgkmcnt(9)
    v_mfma_f32_16x16x32_bf16 v[204:207], v[48:51], v[120:123], v[204:207]
    s_nop 0
    v_permlane32_swap_b32 v9, v11
    s_waitcnt lgkmcnt(8)
    v_mfma_f32_16x16x32_bf16 v[204:207], v[52:55], v[124:127], v[204:207]
    v_add_f32 v9, v9, v11
    s_waitcnt lgkmcnt(7)
    v_mfma_f32_16x16x32_bf16 v[204:207], v[56:59], v[128:131], v[204:207]
    v_mov_b32 v10, v9
    s_waitcnt lgkmcnt(6)
    v_mfma_f32_16x16x32_bf16 v[204:207], v[60:63], v[132:135], v[204:207]
    v_permlane16_swap_b32 v9, v10
    s_waitcnt lgkmcnt(5)
    v_mfma_f32_16x16x32_bf16 v[204:207], v[64:67], v[136:139], v[204:207]
    v_add_f32 v9, v9, v10
    s_waitcnt lgkmcnt(4)
    v_mfma_f32_16x16x32_bf16 v[204:207], v[68:71], v[140:143], v[204:207]
    v_add_f32_dpp v9, v9, v9 row_ror:8 row_mask:0xf bank_mask:0xf
    s_waitcnt lgkmcnt(3)
    v_mfma_f32_16x16x32_bf16 v[204:207], v[72:75], v[144:147], v[204:207]
    v_add_f32_dpp v9, v9, v9 row_ror:4 row_mask:0xf bank_mask:0xf
    s_waitcnt lgkmcnt(2)
    v_mfma_f32_16x16x32_bf16 v[204:207], v[76:79], v[148:151], v[204:207]
    v_add_f32_dpp v9, v9, v9 row_ror:2 row_mask:0xf bank_mask:0xf
    s_waitcnt lgkmcnt(1)
    v_mfma_f32_16x16x32_bf16 v[204:207], v[80:83], v[152:155], v[204:207]
    v_add_f32_dpp v9, v9, v9 row_ror:1 row_mask:0xf bank_mask:0xf
    s_waitcnt lgkmcnt(0)
    v_mfma_f32_16x16x32_bf16 v[204:207], v[84:87], v[156:159], v[204:207]
    v_mov_b32 v11, v9
    s_nop 1
    v_permlane32_swap_b32 v9, v11
    v_mul_f32 v14, 0xbae38e39, v9
    v_mul_f32 v10, v14, v14
    v_fma_f32 v12, v11, s70, -v10
    v_max_f32 v12, 0, v12
    v_add_f32 v12, 0x3727c5ac, v12
    v_rsq_f32 v12, v12
    v_permlane32_swap_b32 v204, v205
    v_fma_f32 v9, v14, v205, v204
    v_mul_f32 v9, v9, v12
    v_cvt_pk_bf16_f32 v9, v9, v9
    v_lshlrev_b32 v9, 16, v9
    v_mul_f32 v10, v9, v9
    v_fma_f32 v10, v10, s71, 1.0
    v_mul_f32 v10, v10, v9
    v_mul_f32 v10, 0xc0135761, v10
    v_exp_f32 v10, v10
    v_mul_f32_dpp v11, v9, v9 row_ror:8 row_mask:0xf bank_mask:0xf
    v_add_f32 v10, 1.0, v10
    v_rcp_f32 v10, v10
    s_mov_b64 exec, 0xff
    v_mul_f32 v10, v10, v11
    v_cvt_pk_bf16_f32 v10, v10, v10
    ds_write_b16 v241, v10
    s_mov_b64 exec, -1
    s_waitcnt lgkmcnt(0)
    s_barrier
    ds_read_b128 v[16:19], v242 offset:0
    ds_read_b128 v[20:23], v242 offset:16
    ds_read_b128 v[24:27], v242 offset:32
    ds_read_b128 v[28:31], v242 offset:48
    ds_read_b128 v[32:35], v242 offset:64
    ds_read_b128 v[36:39], v242 offset:80
    ds_read_b128 v[40:43], v242 offset:96
    ds_read_b128 v[44:47], v242 offset:112
    ds_read_b128 v[48:51], v242 offset:128
    s_waitcnt lgkmcnt(8)
    v_mfma_f32_16x16x32_bf16 v[204:207], v[160:163], v[16:19], 0
    s_waitcnt lgkmcnt(7)
    v_mfma_f32_16x16x32_bf16 v[204:207], v[164:167], v[20:23], v[204:207]
    s_waitcnt lgkmcnt(6)
    v_mfma_f32_16x16x32_bf16 v[204:207], v[168:171], v[24:27], v[204:207]
    s_waitcnt lgkmcnt(5)
    v_mfma_f32_16x16x32_bf16 v[204:207], v[172:175], v[28:31], v[204:207]
    s_waitcnt lgkmcnt(4)
    v_mfma_f32_16x16x32_bf16 v[204:207], v[176:179], v[32:35], v[204:207]
    s_waitcnt lgkmcnt(3)
    v_mfma_f32_16x16x32_bf16 v[204:207], v[180:183], v[36:39], v[204:207]
    s_waitcnt lgkmcnt(2)
    v_mfma_f32_16x16x32_bf16 v[204:207], v[184:187], v[40:43], v[204:207]
    s_waitcnt lgkmcnt(1)
    v_mfma_f32_16x16x32_bf16 v[204:207], v[188:191], v[44:47], v[204:207]
    s_waitcnt lgkmcnt(0)
    v_mfma_f32_16x16x32_bf16 v[204:207], v[192:195], v[48:51], v[204:207]
    s_mov_b32 exec_lo, 0x01ff01ff
    s_mov_b32 exec_hi, 0x01ff01ff
    s_nop 5
    buffer_store_dwordx4 v[204:207], v246, s[36:39], s59 offen sc1
    s_mov_b64 exec, -1
    s_and_b32 s64, s55, 3
    s_or_b32 s64, s64, s3
    s_cmp_lg_u32 s64, 0
    s_cbranch_scc1 L_fin
    s_lshr_b32 s67, s55, 2
    s_mul_i32 s64, s67, 9216
    s_add_u32 s64, s64, 458752
    s_add_u32 s65, s64, 4096
    s_add_u32 s66, s64, 8192
    v_lshrrev_b32 v13, 4, v1
    v_and_b32 v12, 3, v1
    v_lshlrev_b32 v12, 3, v12
    v_and_b32 v10, 1, v13
    v_lshl_add_u32 v12, v10, 2, v12
    v_and_b32 v10, 2, v13
    v_add_u32 v12, v10, v12
    s_lshl_b32 s67, s67, 5
    v_add_u32 v12, s67, v12
    v_add_u32 v11, 129056, v12
    ds_read_u16 v11, v11
    s_waitcnt lgkmcnt(0)
    v_lshlrev_b32 v11, 16, v11
    s_waitcnt vmcnt(0)
    buffer_load_dwordx4 v[88:91], v4, s[36:39], s64 offen offset:0 sc1
    buffer_load_dwordx4 v[92:95], v4, s[36:39], s64 offen offset:1024 sc1
    buffer_load_dwordx4 v[96:99], v4, s[36:39], s64 offen offset:2048 sc1
    buffer_load_dwordx4 v[100:103], v4, s[36:39], s64 offen offset:3072 sc1
    buffer_load_dwordx4 v[104:107], v4, s[36:39], s65 offen offset:0 sc1
    buffer_load_dwordx4 v[108:111], v4, s[36:39], s65 offen offset:1024 sc1
    buffer_load_dwordx4 v[112:115], v4, s[36:39], s65 offen offset:2048 sc1
    buffer_load_dwordx4 v[116:119], v4, s[36:39], s65 offen offset:3072 sc1
    buffer_load_dwordx4 v[120:123], v4, s[36:39], s66 offen offset:0 sc1
L_h3poll:
    buffer_load_dwordx4 v[144:147], v4, s[36:39], s64 offen offset:0 sc1
    buffer_load_dwordx4 v[148:151], v4, s[36:39], s64 offen offset:1024 sc1
    buffer_load_dwordx4 v[152:155], v4, s[36:39], s64 offen offset:2048 sc1
    buffer_load_dwordx4 v[156:159], v4, s[36:39], s64 offen offset:3072 sc1
    buffer_load_dwordx4 v[160:163], v4, s[36:39], s65 offen offset:0 sc1
    buffer_load_dwordx4 v[164:167], v4, s[36:39], s65 offen offset:1024 sc1
    buffer_load_dwordx4 v[168:171], v4, s[36:39], s65 offen offset:2048 sc1
    buffer_load_dwordx4 v[172:175], v4, s[36:39], s65 offen offset:3072 sc1
    buffer_load_dwordx4 v[176:179], v4, s[36:39], s66 offen offset:0 sc1
    s_waitcnt vmcnt(9)
    v_pk_add_f32 v[124:125], v[88:89], v[92:93]
    v_pk_add_f32 v[126:127], v[90:91], v[94:95]
    v_pk_add_f32 v[128:129], v[96:97], v[100:101]
    v_pk_add_f32 v[130:131], v[98:99], v[102:103]
    v_pk_add_f32 v[132:133], v[104:105], v[108:109]
    v_pk_add_f32 v[134:135], v[106:107], v[110:111]
    v_pk_add_f32 v[136:137], v[112:113], v[116:117]
    v_pk_add_f32 v[138:139], v[114:115], v[118:119]
    v_pk_add_f32 v[124:125], v[124:125], v[128:129]
    v_pk_add_f32 v[126:127], v[126:127], v[130:131]
    v_pk_add_f32 v[132:133], v[132:133], v[136:137]
    v_pk_add_f32 v[134:135], v[134:135], v[138:139]
    v_pk_add_f32 v[124:125], v[124:125], v[120:121]
    v_pk_add_f32 v[126:127], v[126:127], v[122:123]
    v_pk_add_f32 v[124:125], v[124:125], v[132:133]
    v_pk_add_f32 v[126:127], v[126:127], v[134:135]
    s_nop 0
    v_permlane32_swap_b32 v124, v125
    v_permlane32_swap_b32 v126, v127
    v_add_f32 v124, v124, v125
    v_add_f32 v126, v126, v127
    s_nop 1
    v_permlane16_swap_b32 v124, v126
    v_add_f32 v124, v124, v126
    s_nop 1
    v_add_f32_dpp v124, v124, v124 row_ror:8 row_mask:0xf bank_mask:0xf
    s_nop 1
    v_add_f32_dpp v124, v124, v124 row_ror:4 row_mask:0xf bank_mask:0xf
    v_cmp_u_f32 vcc, v124, v124
    v_add_f32 v10, v124, v11
    s_cbranch_vccz L_h3ok
    v_max_u32 v9, v88, v89
    v_max3_u32 v9, v9, v90, v91
    v_max3_u32 v9, v9, v92, v93
    v_max3_u32 v9, v9, v94, v95
    v_max3_u32 v9, v9, v96, v97
    v_max3_u32 v9, v9, v98, v99
    v_max3_u32 v9, v9, v100, v101
    v_max3_u32 v9, v9, v102, v103
    v_max3_u32 v9, v9, v104, v105
    v_max3_u32 v9, v9, v106, v107
    v_max3_u32 v9, v9, v108, v109
    v_max3_u32 v9, v9, v110, v111
    v_max3_u32 v9, v9, v112, v113
    v_max3_u32 v9, v9, v114, v115
    v_max3_u32 v9, v9, v116, v117
    v_max3_u32 v9, v9, v118, v119
    v_max3_u32 v9, v9, v120, v121
    v_max3_u32 v9, v9, v122, v123
    v_cmp_eq_u32 vcc, -1, v9
    s_cbranch_vccz L_h3ok
    buffer_load_dwordx4 v[88:91], v4, s[36:39], s64 offen offset:0 sc1
    buffer_load_dwordx4 v[92:95], v4, s[36:39], s64 offen offset:1024 sc1
    buffer_load_dwordx4 v[96:99], v4, s[36:39], s64 offen offset:2048 sc1
    buffer_load_dwordx4 v[100:103], v4, s[36:39], s64 offen offset:3072 sc1
    buffer_load_dwordx4 v[104:107], v4, s[36:39], s65 offen offset:0 sc1
    buffer_load_dwordx4 v[108:111], v4, s[36:39], s65 offen offset:1024 sc1
    buffer_load_dwordx4 v[112:115], v4, s[36:39], s65 offen offset:2048 sc1
    buffer_load_dwordx4 v[116:119], v4, s[36:39], s65 offen offset:3072 sc1
    buffer_load_dwordx4 v[120:123], v4, s[36:39], s66 offen offset:0 sc1
    s_waitcnt vmcnt(9)
    v_pk_add_f32 v[124:125], v[144:145], v[148:149]
    v_pk_add_f32 v[126:127], v[146:147], v[150:151]
    v_pk_add_f32 v[128:129], v[152:153], v[156:157]
    v_pk_add_f32 v[130:131], v[154:155], v[158:159]
    v_pk_add_f32 v[132:133], v[160:161], v[164:165]
    v_pk_add_f32 v[134:135], v[162:163], v[166:167]
    v_pk_add_f32 v[136:137], v[168:169], v[172:173]
    v_pk_add_f32 v[138:139], v[170:171], v[174:175]
    v_pk_add_f32 v[124:125], v[124:125], v[128:129]
    v_pk_add_f32 v[126:127], v[126:127], v[130:131]
    v_pk_add_f32 v[132:133], v[132:133], v[136:137]
    v_pk_add_f32 v[134:135], v[134:135], v[138:139]
    v_pk_add_f32 v[124:125], v[124:125], v[176:177]
    v_pk_add_f32 v[126:127], v[126:127], v[178:179]
    v_pk_add_f32 v[124:125], v[124:125], v[132:133]
    v_pk_add_f32 v[126:127], v[126:127], v[134:135]
    s_nop 0
    v_permlane32_swap_b32 v124, v125
    v_permlane32_swap_b32 v126, v127
    v_add_f32 v124, v124, v125
    v_add_f32 v126, v126, v127
    s_nop 1
    v_permlane16_swap_b32 v124, v126
    v_add_f32 v124, v124, v126
    s_nop 1
    v_add_f32_dpp v124, v124, v124 row_ror:8 row_mask:0xf bank_mask:0xf
    s_nop 1
    v_add_f32_dpp v124, v124, v124 row_ror:4 row_mask:0xf bank_mask:0xf
    v_cmp_u_f32 vcc, v124, v124
    v_add_f32 v10, v124, v11
    s_cbranch_vccz L_h3ok
    v_max_u32 v9, v144, v145
    v_max3_u32 v9, v9, v146, v147
    v_max3_u32 v9, v9, v148, v149
    v_max3_u32 v9, v9, v150, v151
    v_max3_u32 v9, v9, v152, v153
    v_max3_u32 v9, v9, v154, v155
    v_max3_u32 v9, v9, v156, v157
    v_max3_u32 v9, v9, v158, v159
    v_max3_u32 v9, v9, v160, v161
    v_max3_u32 v9, v9, v162, v163
    v_max3_u32 v9, v9, v164, v165
    v_max3_u32 v9, v9, v166, v167
    v_max3_u32 v9, v9, v168, v169
    v_max3_u32 v9, v9, v170, v171
    v_max3_u32 v9, v9, v172, v173
    v_max3_u32 v9, v9, v174, v175
    v_max3_u32 v9, v9, v176, v177
    v_max3_u32 v9, v9, v178, v179
    v_cmp_eq_u32 vcc, -1, v9
    s_cbranch_vccz L_h3ok
    s_sub_u32 s63, s63, 1
    s_cmp_eq_u32 s63, 0
    s_cbranch_scc1 L_end
    s_branch L_h3poll
L_h3ok:
    v_cvt_pk_bf16_f32 v10, v10, v10
    s_mov_b32 exec_lo, 0x000f000f
    s_mov_b32 exec_hi, 0x000f000f
    buffer_store_short v10, v12, s[48:51], 0 offen
    s_cmp_lg_u32 s55, 0
    s_cbranch_scc1 L_fin
    s_mov_b64 exec, 1
    v_mov_b32 v9, s56
    v_mov_b32 v10, 0
    buffer_store_dword v9, v10, s[36:39], 0 offen offset:0
L_fin:
L_end:
    s_endpgm
L_extra:
    s_cmp_eq_u32 s58, 3
    s_cbranch_scc1 L_setup
    s_cmp_eq_u32 s58, 1
    s_cbranch_scc1 L_confchk
    s_mov_b32 s64, 24576
    buffer_load_dwordx4 v[252:255], v4, s[36:39], s64 offen
    s_branch L_nochk
L_confchk:
    v_cmp_ne_u32 vcc, s56, v252
    v_cmp_ne_u32 s[80:81], s56, v253
    s_nop 0
    s_or_b64 vcc, vcc, s[80:81]
    v_cmp_ne_u32 s[80:81], s56, v254
    s_nop 0
    s_or_b64 vcc, vcc, s[80:81]
    v_cmp_ne_u32 s[80:81], s56, v255
    s_nop 0
    s_or_b64 vcc, vcc, s[80:81]
    s_cbranch_vccz L_confok
    s_mov_b32 s64, 24576
    buffer_load_dwordx4 v[252:255], v4, s[36:39], s64 offen sc1
    s_waitcnt vmcnt(0)
    s_sub_u32 s63, s63, 1
    s_cmp_eq_u32 s63, 0
    s_cbranch_scc1 L_end
    s_branch L_confchk
L_confok:
    s_mov_b32 s60, 1
    s_atomic_add s60, s[26:27], s61 glc
    s_branch L_nochk
L_setup:
    s_cmp_eq_u32 s54, 2
    s_cbranch_scc1 L_nochk
    v_mov_b32 v9, 130784
L_lw3:
    ds_read_b32 v10, v9 offset:4
    s_waitcnt lgkmcnt(0)
    v_cmp_eq_u32 vcc, 1, v10
    s_cbranch_vccnz L_lw3ok
    s_sub_u32 s63, s63, 1
    s_cmp_eq_u32 s63, 0
    s_cbranch_scc1 L_end
    s_branch L_lw3
L_lw3ok:
    v_lshrrev_b32 v13, 4, v1
    v_bfe_u32 v14, v1, 2, 2
    v_and_b32 v15, 3, v1
    v_lshlrev_b32 v243, 4, v13
    v_lshl_add_u32 v9, v13, 3, v14
    v_and_b32 v12, 15, v1
    v_lshlrev_b32 v12, 3, v12
    v_and_b32 v10, 1, v13
    v_lshl_add_u32 v12, v10, 2, v12
    v_and_b32 v10, 2, v13
    v_add_u32 v12, v10, v12
    s_cmp_eq_u32 s54, 0
    s_cbranch_scc1 L_setup_ffn
    s_lshl_b32 s64, s3, 8
    s_add_u32 s64, s64, 131072
    v_add_u32 v242, s64, v12
    v_add_u32 v244, 131072, v243
    v_add_u32 v10, v13, v1
    v_and_b32 v10, 15, v10
    v_lshlrev_b32 v237, 7, v10
    s_and_b32 s66, s52, 14
    s_lshr_b32 s64, s3, 1
    s_add_u32 s66, s66, s64
    s_and_b32 s67, s3, 1
    s_lshl_b32 s64, s66, 11
    s_lshl_b32 s65, s67, 3
    s_add_u32 s64, s64, s65
    s_add_u32 s0, s64, 65536
    s_lshl_b32 s64, s66, 14
    s_lshl_b32 s65, s67, 9
    s_add_u32 s64, s64, s65
    s_add_u32 s1, s64, 131072
    v_and_b32 v10, 15, v1
    v_lshlrev_b32 v10, 4, v10
    v_lshl_add_u32 v238, v13, 10, v10
    v_add_u32 v239, 4096, v238
    v_add_u32 v240, 8192, v238
    v_add_u32 v241, 12288, v238
    s_lshl_b32 s64, s55, 11
    s_lshr_b32 s65, s52, 1
    s_lshl_b32 s65, s65, 8
    s_add_u32 s64, s64, s65
    s_lshl_b32 s65, s3, 6
    s_add_u32 s64, s64, s65
    s_add_u32 s98, s64, 393216
    v_lshlrev_b32 v10, 7, v9
    v_lshl_add_u32 v10, v15, 3, v10
    s_lshl_b32 s64, s3, 5
    v_add_u32 v10, s64, v10
    ds_read_b64_tr_b16 v[88:89], v10 offset:0
    ds_read_b64_tr_b16 v[90:91], v10 offset:512
    ds_read_b64_tr_b16 v[92:93], v10 offset:4096
    ds_read_b64_tr_b16 v[94:95], v10 offset:4608
    ds_read_b64_tr_b16 v[96:97], v10 offset:8192
    ds_read_b64_tr_b16 v[98:99], v10 offset:8704
    ds_read_b64_tr_b16 v[100:101], v10 offset:12288
    ds_read_b64_tr_b16 v[102:103], v10 offset:12800
    ds_read_b64_tr_b16 v[104:105], v10 offset:16384
    ds_read_b64_tr_b16 v[106:107], v10 offset:16896
    ds_read_b64_tr_b16 v[108:109], v10 offset:20480
    ds_read_b64_tr_b16 v[110:111], v10 offset:20992
    ds_read_b64_tr_b16 v[112:113], v10 offset:24576
    ds_read_b64_tr_b16 v[114:115], v10 offset:25088
    ds_read_b64_tr_b16 v[116:117], v10 offset:28672
    ds_read_b64_tr_b16 v[118:119], v10 offset:29184
    ds_read_b64_tr_b16 v[120:121], v10 offset:32768
    ds_read_b64_tr_b16 v[122:123], v10 offset:33280
    ds_read_b64_tr_b16 v[124:125], v10 offset:36864
    ds_read_b64_tr_b16 v[126:127], v10 offset:37376
    ds_read_b64_tr_b16 v[128:129], v10 offset:40960
    ds_read_b64_tr_b16 v[130:131], v10 offset:41472
    ds_read_b64_tr_b16 v[132:133], v10 offset:45056
    ds_read_b64_tr_b16 v[134:135], v10 offset:45568
    ds_read_b64_tr_b16 v[136:137], v10 offset:49152
    ds_read_b64_tr_b16 v[138:139], v10 offset:49664
    ds_read_b64_tr_b16 v[140:141], v10 offset:53248
    ds_read_b64_tr_b16 v[142:143], v10 offset:53760
    ds_read_b64_tr_b16 v[144:145], v10 offset:57344
    ds_read_b64_tr_b16 v[146:147], v10 offset:57856
    ds_read_b64_tr_b16 v[148:149], v10 offset:61440
    ds_read_b64_tr_b16 v[150:151], v10 offset:61952
    s_waitcnt lgkmcnt(0)
    s_branch L_nochk
L_setup_ffn:
    s_lshl_b32 s64, s3, 7
    v_add_u32 v12, s64, v12
    buffer_load_ushort v232, v12, s[44:47], 0 offen offset:0
    buffer_load_ushort v233, v12, s[44:47], 0 offen offset:512
    buffer_load_ushort v234, v12, s[44:47], 0 offen offset:1024
    v_add_u32 v237, 129056, v12
    v_add_u32 v238, 129056, v243
    v_add_u32 v239, 129056, v4
    v_lshlrev_b32 v10, 1, v1
    v_add_u32 v240, 129056, v10
    v_lshlrev_b32 v10, 6, v9
    v_and_b32 v11, 1, v15
    v_lshl_add_u32 v10, v11, 3, v10
    v_lshrrev_b32 v11, 1, v15
    v_and_b32 v14, 1, v13
    v_lshlrev_b32 v14, 1, v14
    v_xor_b32 v14, s3, v14
    v_mul_u32_u24 v11, 36880, v11
    v_lshl_add_u32 v11, v14, 4, v11
    v_add_u32 v244, v10, v11
    v_bfe_u32 v11, v9, 1, 1
    v_bfe_u32 v14, v9, 3, 1
    v_lshl_or_b32 v11, v14, 1, v11
    v_mul_u32_u24 v10, 1152, v9
    v_lshl_add_u32 v10, v15, 3, v10
    v_add_u32 v10, 73760, v10
    s_mul_i32 s64, s3, 9
    s_add_u32 s64, s64, 0
    v_xor_b32 v14, s64, v11
    v_lshl_add_u32 v248, v14, 5, v10
    s_mul_i32 s64, s3, 9
    s_add_u32 s64, s64, 1
    v_xor_b32 v14, s64, v11
    v_lshl_add_u32 v249, v14, 5, v10
    s_mul_i32 s64, s3, 9
    s_add_u32 s64, s64, 2
    v_xor_b32 v14, s64, v11
    v_lshl_add_u32 v250, v14, 5, v10
    s_mul_i32 s64, s3, 9
    s_add_u32 s64, s64, 3
    v_xor_b32 v14, s64, v11
    v_lshl_add_u32 v251, v14, 5, v10
    s_mul_i32 s64, s3, 3584
    s_add_u32 s64, s64, 134144
    v_lshl_add_u32 v245, v1, 2, s64
    s_sub_u32 s64, s64, 129056
    v_bfe_u32 v10, v1, 3, 1
    v_mul_u32_u24 v10, s64, v10
    v_add_u32 v238, v238, v10
    s_waitcnt lgkmcnt(0)
    s_branch L_nochk
L_w4:
    v_mov_b32 v88, -1
    v_mov_b32 v89, -1
    v_mov_b32 v90, -1
    v_mov_b32 v91, -1
    v_lshlrev_b32 v9, 2, v1
    v_add_u32 v9, 130784, v9
    v_mov_b32 v10, 0
    s_mov_b64 exec, 0xff
    ds_write_b32 v9, v10
    s_mov_b64 exec, -1
    v_lshrrev_b32 v11, 3, v1
    v_and_b32 v12, 7, v1
    v_mul_u32_u24 v9, 1152, v11
    v_lshl_add_u32 v94, v12, 4, v9
    v_lshrrev_b32 v11, 2, v1
    v_and_b32 v12, 3, v1
    v_lshrrev_b32 v10, 5, v1
    v_lshlrev_b32 v10, 1, v10
    v_xor_b32 v10, v10, v12
    v_mul_u32_u24 v9, 9216, v11
    v_lshl_add_u32 v92, v10, 4, v9
    s_waitcnt lgkmcnt(0)
    s_barrier
    s_add_u32 s56, s56, 2654435769
    s_cmp_eq_u32 s54, 2
    s_cbranch_scc1 L_dma_done
    s_cmp_eq_u32 s54, 1
    s_cbranch_scc1 L_dma_wo
    s_mov_b32 s40, s16
    s_and_b32 s41, s17, 0xffff
    s_mov_b32 s42, 5308416
    s_mov_b32 s43, 0x20000
    s_lshl_b32 s64, s55, 6
    s_mov_b32 s65, 0
    s_mov_b32 s58, 18
L_dma4:
    s_mov_b32 m0, s65
    s_waitcnt vmcnt(32)
    buffer_load_dwordx4 v92, s[40:43], s64 offen nt lds
    s_add_u32 s64, s64, 147456
    s_add_u32 s65, s65, 1024
    s_mov_b32 m0, s65
    s_waitcnt vmcnt(32)
    buffer_load_dwordx4 v92, s[40:43], s64 offen nt lds
    s_add_u32 s64, s64, 147456
    s_add_u32 s65, s65, 1024
    s_sub_u32 s58, s58, 1
    s_cmp_lg_u32 s58, 0
    s_cbranch_scc1 L_dma4
    v_mul_u32_u24 v9, 9216, v11
    v_lshl_add_u32 v9, v12, 4, v9
    s_lshl_b32 s64, s55, 6
    s_add_u32 s64, s64, 458752
    buffer_store_dwordx4 v[88:91], v9, s[36:39], s64 offen sc1
    s_add_u32 s64, s64, 147456
    buffer_store_dwordx4 v[88:91], v9, s[36:39], s64 offen sc1
    s_add_u32 s64, s64, 147456
    s_mov_b64 exec, 0xffff
    buffer_store_dwordx4 v[88:91], v9, s[36:39], s64 offen sc1
    s_mov_b64 exec, -1
    s_branch L_dma_done
L_dma_wo:
    s_mov_b32 s40, s12
    s_and_b32 s41, s13, 0xffff
    s_mov_b32 s42, 4718592
    s_mov_b32 s43, 0x20000
    s_lshr_b32 s66, s52, 1
    s_mul_i32 s64, s66, 589824
    s_lshl_b32 s65, s55, 7
    s_add_u32 s64, s64, s65
    s_mov_b32 s65, 0
    s_mov_b32 s58, 32
L_dma5:
    s_mov_b32 m0, s65
    s_waitcnt vmcnt(32)
    buffer_load_dwordx4 v94, s[40:43], s64 offen nt lds
    s_add_u32 s64, s64, 9216
    s_add_u32 s65, s65, 1024
    s_mov_b32 m0, s65
    s_waitcnt vmcnt(32)
    buffer_load_dwordx4 v94, s[40:43], s64 offen nt lds
    s_add_u32 s64, s64, 9216
    s_add_u32 s65, s65, 1024
    s_sub_u32 s58, s58, 1
    s_cmp_lg_u32 s58, 0
    s_cbranch_scc1 L_dma5
    s_lshl_b32 s64, s55, 11
    s_lshl_b32 s66, s66, 8
    s_add_u32 s64, s64, s66
    s_add_u32 s64, s64, 393216
    s_mov_b64 exec, 0xffff
    buffer_store_dwordx4 v[88:91], v4, s[36:39], s64 offen sc1
    s_mov_b64 exec, -1
L_dma_done:
    s_lshl_b32 s64, s2, 10
    s_add_u32 s64, s64, 131072
    buffer_store_dwordx4 v[88:91], v4, s[36:39], s64 offen sc1
    s_lshl_b32 s64, s2, 7
    s_add_u32 s64, s64, 65536
    s_mov_b64 exec, 1
    buffer_store_dwordx4 v[88:91], v4, s[36:39], s64 offen sc1
    s_mov_b64 exec, -1
    s_cmp_lg_u32 s53, 0
    s_cbranch_scc1 L_noctr
    v_mov_b32 v9, 0
    v_mul_u32_u24 v10, 256, v1
    s_mul_i32 s64, s52, 1024
    s_add_u32 s64, s64, 1048576
    s_mov_b64 exec, 15
    buffer_store_dword v9, v10, s[36:39], s64 offen sc1
    s_mov_b64 exec, -1
L_noctr:
    s_waitcnt vmcnt(0)
    v_mov_b32 v9, 130784
    v_mov_b32 v10, 1
    ds_write_b32 v9, v10 offset:4
    s_lshl_b32 s64, s2, 2
    s_add_u32 s64, s64, 24576
    v_mov_b32 v9, 0
    v_mov_b32 v10, s56
    s_mov_b64 exec, 1
    buffer_store_dword v10, v9, s[36:39], s64 offen sc1
    s_mov_b64 exec, -1
    s_cmp_lg_u32 s54, 0
    s_cbranch_scc1 L_end
    v_add_u32 v10, 0, v1
    v_mul_u32_u24 v11, 911, v10
    v_lshrrev_b32 v11, 16, v11
    v_bfe_u32 v12, v11, 1, 1
    v_bfe_u32 v9, v11, 3, 1
    v_lshl_or_b32 v12, v9, 1, v12
    v_lshlrev_b32 v12, 1, v12
    v_mul_u32_u24 v11, 72, v11
    v_sub_u32 v10, v10, v11
    v_xor_b32 v10, v10, v12
    v_add_lshl_u32 v96, v10, v11, 4
    v_add_u32 v10, 64, v1
    v_mul_u32_u24 v11, 911, v10
    v_lshrrev_b32 v11, 16, v11
    v_bfe_u32 v12, v11, 1, 1
    v_bfe_u32 v9, v11, 3, 1
    v_lshl_or_b32 v12, v9, 1, v12
    v_lshlrev_b32 v12, 1, v12
    v_mul_u32_u24 v11, 72, v11
    v_sub_u32 v10, v10, v11
    v_xor_b32 v10, v10, v12
    v_add_lshl_u32 v97, v10, v11, 4
    v_add_u32 v10, 128, v1
    v_mul_u32_u24 v11, 911, v10
    v_lshrrev_b32 v11, 16, v11
    v_bfe_u32 v12, v11, 1, 1
    v_bfe_u32 v9, v11, 3, 1
    v_lshl_or_b32 v12, v9, 1, v12
    v_lshlrev_b32 v12, 1, v12
    v_mul_u32_u24 v11, 72, v11
    v_sub_u32 v10, v10, v11
    v_xor_b32 v10, v10, v12
    v_add_lshl_u32 v98, v10, v11, 4
    v_add_u32 v10, 192, v1
    v_mul_u32_u24 v11, 911, v10
    v_lshrrev_b32 v11, 16, v11
    v_bfe_u32 v12, v11, 1, 1
    v_bfe_u32 v9, v11, 3, 1
    v_lshl_or_b32 v12, v9, 1, v12
    v_lshlrev_b32 v12, 1, v12
    v_mul_u32_u24 v11, 72, v11
    v_sub_u32 v10, v10, v11
    v_xor_b32 v10, v10, v12
    v_add_lshl_u32 v99, v10, v11, 4
    v_add_u32 v10, 256, v1
    v_mul_u32_u24 v11, 911, v10
    v_lshrrev_b32 v11, 16, v11
    v_bfe_u32 v12, v11, 1, 1
    v_bfe_u32 v9, v11, 3, 1
    v_lshl_or_b32 v12, v9, 1, v12
    v_lshlrev_b32 v12, 1, v12
    v_mul_u32_u24 v11, 72, v11
    v_sub_u32 v10, v10, v11
    v_xor_b32 v10, v10, v12
    v_add_lshl_u32 v100, v10, v11, 4
    v_add_u32 v10, 320, v1
    v_mul_u32_u24 v11, 911, v10
    v_lshrrev_b32 v11, 16, v11
    v_bfe_u32 v12, v11, 1, 1
    v_bfe_u32 v9, v11, 3, 1
    v_lshl_or_b32 v12, v9, 1, v12
    v_lshlrev_b32 v12, 1, v12
    v_mul_u32_u24 v11, 72, v11
    v_sub_u32 v10, v10, v11
    v_xor_b32 v10, v10, v12
    v_add_lshl_u32 v101, v10, v11, 4
    v_add_u32 v10, 384, v1
    v_mul_u32_u24 v11, 911, v10
    v_lshrrev_b32 v11, 16, v11
    v_bfe_u32 v12, v11, 1, 1
    v_bfe_u32 v9, v11, 3, 1
    v_lshl_or_b32 v12, v9, 1, v12
    v_lshlrev_b32 v12, 1, v12
    v_mul_u32_u24 v11, 72, v11
    v_sub_u32 v10, v10, v11
    v_xor_b32 v10, v10, v12
    v_add_lshl_u32 v102, v10, v11, 4
    v_add_u32 v10, 448, v1
    v_mul_u32_u24 v11, 911, v10
    v_lshrrev_b32 v11, 16, v11
    v_bfe_u32 v12, v11, 1, 1
    v_bfe_u32 v9, v11, 3, 1
    v_lshl_or_b32 v12, v9, 1, v12
    v_lshlrev_b32 v12, 1, v12
    v_mul_u32_u24 v11, 72, v11
    v_sub_u32 v10, v10, v11
    v_xor_b32 v10, v10, v12
    v_add_lshl_u32 v103, v10, v11, 4
    v_add_u32 v10, 512, v1
    v_mul_u32_u24 v11, 911, v10
    v_lshrrev_b32 v11, 16, v11
    v_bfe_u32 v12, v11, 1, 1
    v_bfe_u32 v9, v11, 3, 1
    v_lshl_or_b32 v12, v9, 1, v12
    v_lshlrev_b32 v12, 1, v12
    v_mul_u32_u24 v11, 72, v11
    v_sub_u32 v10, v10, v11
    v_xor_b32 v10, v10, v12
    v_add_lshl_u32 v104, v10, v11, 4
    v_add_u32 v10, 576, v1
    v_mul_u32_u24 v11, 911, v10
    v_lshrrev_b32 v11, 16, v11
    v_bfe_u32 v12, v11, 1, 1
    v_bfe_u32 v9, v11, 3, 1
    v_lshl_or_b32 v12, v9, 1, v12
    v_lshlrev_b32 v12, 1, v12
    v_mul_u32_u24 v11, 72, v11
    v_sub_u32 v10, v10, v11
    v_xor_b32 v10, v10, v12
    v_add_lshl_u32 v105, v10, v11, 4
    v_add_u32 v10, 640, v1
    v_mul_u32_u24 v11, 911, v10
    v_lshrrev_b32 v11, 16, v11
    v_bfe_u32 v12, v11, 1, 1
    v_bfe_u32 v9, v11, 3, 1
    v_lshl_or_b32 v12, v9, 1, v12
    v_lshlrev_b32 v12, 1, v12
    v_mul_u32_u24 v11, 72, v11
    v_sub_u32 v10, v10, v11
    v_xor_b32 v10, v10, v12
    v_add_lshl_u32 v106, v10, v11, 4
    v_add_u32 v10, 704, v1
    v_mul_u32_u24 v11, 911, v10
    v_lshrrev_b32 v11, 16, v11
    v_bfe_u32 v12, v11, 1, 1
    v_bfe_u32 v9, v11, 3, 1
    v_lshl_or_b32 v12, v9, 1, v12
    v_lshlrev_b32 v12, 1, v12
    v_mul_u32_u24 v11, 72, v11
    v_sub_u32 v10, v10, v11
    v_xor_b32 v10, v10, v12
    v_add_lshl_u32 v107, v10, v11, 4
    v_add_u32 v10, 768, v1
    v_mul_u32_u24 v11, 911, v10
    v_lshrrev_b32 v11, 16, v11
    v_bfe_u32 v12, v11, 1, 1
    v_bfe_u32 v9, v11, 3, 1
    v_lshl_or_b32 v12, v9, 1, v12
    v_lshlrev_b32 v12, 1, v12
    v_mul_u32_u24 v11, 72, v11
    v_sub_u32 v10, v10, v11
    v_xor_b32 v10, v10, v12
    v_add_lshl_u32 v108, v10, v11, 4
    v_add_u32 v10, 832, v1
    v_mul_u32_u24 v11, 911, v10
    v_lshrrev_b32 v11, 16, v11
    v_bfe_u32 v12, v11, 1, 1
    v_bfe_u32 v9, v11, 3, 1
    v_lshl_or_b32 v12, v9, 1, v12
    v_lshlrev_b32 v12, 1, v12
    v_mul_u32_u24 v11, 72, v11
    v_sub_u32 v10, v10, v11
    v_xor_b32 v10, v10, v12
    v_add_lshl_u32 v109, v10, v11, 4
    v_add_u32 v10, 896, v1
    v_mul_u32_u24 v11, 911, v10
    v_lshrrev_b32 v11, 16, v11
    v_bfe_u32 v12, v11, 1, 1
    v_bfe_u32 v9, v11, 3, 1
    v_lshl_or_b32 v12, v9, 1, v12
    v_lshlrev_b32 v12, 1, v12
    v_mul_u32_u24 v11, 72, v11
    v_sub_u32 v10, v10, v11
    v_xor_b32 v10, v10, v12
    v_add_lshl_u32 v110, v10, v11, 4
    v_add_u32 v10, 960, v1
    v_mul_u32_u24 v11, 911, v10
    v_lshrrev_b32 v11, 16, v11
    v_bfe_u32 v12, v11, 1, 1
    v_bfe_u32 v9, v11, 3, 1
    v_lshl_or_b32 v12, v9, 1, v12
    v_lshlrev_b32 v12, 1, v12
    v_mul_u32_u24 v11, 72, v11
    v_sub_u32 v10, v10, v11
    v_xor_b32 v10, v10, v12
    v_add_lshl_u32 v111, v10, v11, 4
    v_add_u32 v10, 1024, v1
    v_mul_u32_u24 v11, 911, v10
    v_lshrrev_b32 v11, 16, v11
    v_bfe_u32 v12, v11, 1, 1
    v_bfe_u32 v9, v11, 3, 1
    v_lshl_or_b32 v12, v9, 1, v12
    v_lshlrev_b32 v12, 1, v12
    v_mul_u32_u24 v11, 72, v11
    v_sub_u32 v10, v10, v11
    v_xor_b32 v10, v10, v12
    v_add_lshl_u32 v112, v10, v11, 4
    v_add_u32 v10, 1088, v1
    v_mul_u32_u24 v11, 911, v10
    v_lshrrev_b32 v11, 16, v11
    v_bfe_u32 v12, v11, 1, 1
    v_bfe_u32 v9, v11, 3, 1
    v_lshl_or_b32 v12, v9, 1, v12
    v_lshlrev_b32 v12, 1, v12
    v_mul_u32_u24 v11, 72, v11
    v_sub_u32 v10, v10, v11
    v_xor_b32 v10, v10, v12
    v_add_lshl_u32 v113, v10, v11, 4
    s_mov_b32 s40, s18
    s_and_b32 s41, s19, 0xffff
    s_mov_b32 s42, 5308416
    s_mov_b32 s43, 0x20000
    s_lshl_b32 s64, s55, 6
    s_waitcnt lgkmcnt(0)
    s_barrier
    s_mov_b32 s65, 36880
    s_mov_b32 s58, 18
L_dma6:
    s_mov_b32 m0, s65
    s_waitcnt vmcnt(48)
    buffer_load_dwordx4 v92, s[40:43], s64 offen sc1 nt lds
    s_add_u32 s64, s64, 147456
    s_add_u32 s65, s65, 1024
    s_mov_b32 m0, s65
    s_waitcnt vmcnt(48)
    buffer_load_dwordx4 v92, s[40:43], s64 offen sc1 nt lds
    s_add_u32 s64, s64, 147456
    s_add_u32 s65, s65, 1024
    s_sub_u32 s58, s58, 1
    s_cmp_lg_u32 s58, 0
    s_cbranch_scc1 L_dma6
    s_waitcnt vmcnt(27)
    s_mov_b32 s40, s20
    s_and_b32 s41, s21, 0xffff
    s_mov_b32 s42, 5308416
    s_mov_b32 s43, 0x20000
    s_mul_i32 s64, s55, 36864
    s_mov_b32 m0, 73760
    s_nop 0
    buffer_load_dwordx4 v96, s[40:43], s64 offen nt lds
    s_mov_b32 m0, 74784
    s_nop 0
    buffer_load_dwordx4 v97, s[40:43], s64 offen nt lds
    s_mov_b32 m0, 75808
    s_nop 0
    buffer_load_dwordx4 v98, s[40:43], s64 offen nt lds
    s_mov_b32 m0, 76832
    s_nop 0
    buffer_load_dwordx4 v99, s[40:43], s64 offen nt lds
    s_mov_b32 m0, 77856
    s_nop 0
    buffer_load_dwordx4 v100, s[40:43], s64 offen nt lds
    s_mov_b32 m0, 78880
    s_nop 0
    buffer_load_dwordx4 v101, s[40:43], s64 offen nt lds
    s_mov_b32 m0, 79904
    s_nop 0
    buffer_load_dwordx4 v102, s[40:43], s64 offen nt lds
    s_mov_b32 m0, 80928
    s_nop 0
    buffer_load_dwordx4 v103, s[40:43], s64 offen nt lds
    s_mov_b32 m0, 81952
    s_nop 0
    buffer_load_dwordx4 v104, s[40:43], s64 offen nt lds
    s_mov_b32 m0, 82976
    s_nop 0
    buffer_load_dwordx4 v105, s[40:43], s64 offen nt lds
    s_mov_b32 m0, 84000
    s_nop 0
    buffer_load_dwordx4 v106, s[40:43], s64 offen nt lds
    s_mov_b32 m0, 85024
    s_nop 0
    buffer_load_dwordx4 v107, s[40:43], s64 offen nt lds
    s_mov_b32 m0, 86048
    s_nop 0
    buffer_load_dwordx4 v108, s[40:43], s64 offen nt lds
    s_mov_b32 m0, 87072
    s_nop 0
    buffer_load_dwordx4 v109, s[40:43], s64 offen nt lds
    s_mov_b32 m0, 88096
    s_nop 0
    buffer_load_dwordx4 v110, s[40:43], s64 offen nt lds
    s_mov_b32 m0, 89120
    s_nop 0
    buffer_load_dwordx4 v111, s[40:43], s64 offen nt lds
    s_mov_b32 m0, 90144
    s_nop 0
    buffer_load_dwordx4 v112, s[40:43], s64 offen nt lds
    s_mov_b32 m0, 91168
    s_nop 0
    buffer_load_dwordx4 v113, s[40:43], s64 offen nt lds
    s_add_u32 s64, s64, 18432
    s_mov_b32 m0, 92192
    s_nop 0
    buffer_load_dwordx4 v96, s[40:43], s64 offen nt lds
    s_mov_b32 m0, 93216
    s_nop 0
    buffer_load_dwordx4 v97, s[40:43], s64 offen nt lds
    s_mov_b32 m0, 94240
    s_nop 0
    buffer_load_dwordx4 v98, s[40:43], s64 offen nt lds
    s_mov_b32 m0, 95264
    s_nop 0
    buffer_load_dwordx4 v99, s[40:43], s64 offen nt lds
    s_mov_b32 m0, 96288
    s_nop 0
    buffer_load_dwordx4 v100, s[40:43], s64 offen nt lds
    s_mov_b32 m0, 97312
    s_nop 0
    buffer_load_dwordx4 v101, s[40:43], s64 offen nt lds
    s_mov_b32 m0, 98336
    s_nop 0
    buffer_load_dwordx4 v102, s[40:43], s64 offen nt lds
    s_mov_b32 m0, 99360
    s_nop 0
    buffer_load_dwordx4 v103, s[40:43], s64 offen nt lds
    s_mov_b32 m0, 100384
    s_nop 0
    buffer_load_dwordx4 v104, s[40:43], s64 offen nt lds
    s_mov_b32 m0, 101408
    s_nop 0
    buffer_load_dwordx4 v105, s[40:43], s64 offen nt lds
    s_mov_b32 m0, 102432
    s_nop 0
    buffer_load_dwordx4 v106, s[40:43], s64 offen nt lds
    s_mov_b32 m0, 103456
    s_nop 0
    buffer_load_dwordx4 v107, s[40:43], s64 offen nt lds
    s_mov_b32 m0, 104480
    s_nop 0
    buffer_load_dwordx4 v108, s[40:43], s64 offen nt lds
    s_mov_b32 m0, 105504
    s_nop 0
    buffer_load_dwordx4 v109, s[40:43], s64 offen nt lds
    s_mov_b32 m0, 106528
    s_nop 0
    buffer_load_dwordx4 v110, s[40:43], s64 offen nt lds
    s_mov_b32 m0, 107552
    s_nop 0
    buffer_load_dwordx4 v111, s[40:43], s64 offen nt lds
    s_mov_b32 m0, 108576
    s_nop 0
    buffer_load_dwordx4 v112, s[40:43], s64 offen nt lds
    s_mov_b32 m0, 109600
    s_nop 0
    buffer_load_dwordx4 v113, s[40:43], s64 offen nt lds
    s_add_u32 s64, s64, 18432
    s_waitcnt vmcnt(36)
    v_mov_b32 v9, 130784
    v_mov_b32 v10, 1
    ds_write_b32 v9, v10 offset:12
    s_waitcnt vmcnt(0)
    v_mov_b32 v10, 2
    ds_write_b32 v9, v10 offset:12
    s_endpgm
L_rared:
    v_mov_b32 v10, v9
    s_nop 1
    v_max_f32_dpp v10, v10, v10 quad_perm:[2,3,0,1] row_mask:0xf bank_mask:0xf
    s_nop 1
    v_max_f32_dpp v10, v10, v10 row_ror:4 row_mask:0xf bank_mask:0xf
    s_nop 1
    v_max_f32_dpp v10, v10, v10 row_ror:8 row_mask:0xf bank_mask:0xf
    v_mov_b32 v11, v10
    s_nop 1
    v_permlane16_swap_b32 v10, v11
    v_max_f32 v10, v10, v11
    v_mov_b32 v11, v10
    s_nop 1
    v_permlane32_swap_b32 v10, v11
    v_max_f32 v10, v10, v11
    v_max_f32 v10, v10, v7
    v_sub_f32 v11, v7, v10
    v_mul_f32 v11, s77, v11
    v_exp_f32 v11, v11
    v_mov_b32 v7, v10
    v_mul_f32 v8, v8, v11
    v_readlane_b32 s78, v11, 0
    v_readlane_b32 s79, v11, 1
    s_nop 0
    v_mul_f32 v16, s78, v16
    v_mul_f32 v17, s78, v17
    v_mul_f32 v18, s79, v18
    v_mul_f32 v19, s79, v19
    s_branch L_contd
L_rarex:
    v_mov_b32 v10, v9
    s_nop 1
    v_max_f32_dpp v10, v10, v10 quad_perm:[2,3,0,1] row_mask:0xf bank_mask:0xf
    s_nop 1
    v_max_f32_dpp v10, v10, v10 row_ror:4 row_mask:0xf bank_mask:0xf
    s_nop 1
    v_max_f32_dpp v10, v10, v10 row_ror:8 row_mask:0xf bank_mask:0xf
    v_mov_b32 v11, v10
    s_nop 1
    v_permlane16_swap_b32 v10, v11
    v_max_f32 v10, v10, v11
    v_mov_b32 v11, v10
    s_nop 1
    v_permlane32_swap_b32 v10, v11
    v_max_f32 v10, v10, v11
    v_max_f32 v10, v10, v7
    v_sub_f32 v11, v7, v10
    v_mul_f32 v11, s77, v11
    v_exp_f32 v11, v11
    v_mov_b32 v7, v10
    v_mul_f32 v8, v8, v11
    v_readlane_b32 s78, v11, 0
    v_readlane_b32 s79, v11, 1
    s_nop 0
    v_mul_f32 v16, s78, v16
    v_mul_f32 v17, s78, v17
    v_mul_f32 v18, s79, v18
    v_mul_f32 v19, s79, v19
    s_branch L_contx
.section .rodata,"a"
.p2align 6
.amdhsa_kernel sequential_preLN__gqa_block_cached__geglu_ffn__decode_kernel
  .amdhsa_next_free_vgpr 256
  .amdhsa_next_free_sgpr 102
  .amdhsa_accum_offset 256
  .amdhsa_group_segment_fixed_size 0
  .amdhsa_kernarg_size 96
  .amdhsa_user_sgpr_count 2
  .amdhsa_user_sgpr_kernarg_segment_ptr 1
  .amdhsa_system_sgpr_workgroup_id_x 1
  .amdhsa_float_denorm_mode_32 3
.end_amdhsa_kernel
```
